```python
import torch

def _softmax(x, axis=-1):
    return torch.softmax(x, dim=axis)
def _gelu(x):
    return torch.nn.functional.gelu(x, approximate="tanh")
def _silu(x):
    return torch.nn.functional.silu(x)
def _sigmoid(x):
    return torch.sigmoid(x)
def _layernorm(x, axis=-1, eps=1e-5):
    m = x.mean(dim=axis, keepdim=True)
    v = x.var(dim=axis, keepdim=True, unbiased=False)
    return (x - m) / torch.sqrt(v + eps)
def _scatter_add(tgt, idx, src, axis=0):
    return tgt.clone().index_add_(axis, idx, src)
def _segment_sum(src, seg, n):
    out = torch.zeros((n,) + src.shape[1:], dtype=src.dtype)
    return out.index_add_(0, seg, src)
def _pad(x, pw):
    flat = tuple(v for pair in reversed(pw) for v in pair)
    return torch.nn.functional.pad(x, flat)

kernel_name = 'interleave_layers__gqa_block_cached__glu_gated_reglu__decode'

def setup_inputs():

    _w = (lambda a: (lambda t: t.to(torch.bfloat16) if t.is_floating_point() else t)(torch.as_tensor(a)))
    def _A_setup():
        B, Sq, D = 2, 1, 512
        Hq, Hkv, Sk, Dh = 32, 8, 8192, 128
        assert Hq % Hkv == 0, (Hq, Hkv)
        return {
            "x": _w((lambda *s: torch.randn(*s, dtype=torch.bfloat16) * 0.05)(B, Sq, D)),
            "k_cache": _w((lambda *s: torch.randn(*s, dtype=torch.bfloat16) * 1.6)(B, Hkv, Sk, Dh)),
            "v_cache": _w((lambda *s: torch.randn(*s, dtype=torch.bfloat16) * 0.8)(B, Hkv, Sk, Dh)),
            "wq": _w((lambda *s: torch.randn(*s, dtype=torch.bfloat16) * 1.6)(D, Hq * Dh) * (D ** -0.5)),
            "wo": _w((lambda *s: torch.randn(*s, dtype=torch.bfloat16) * 0.8)(Hq * Dh, D) * ((Hq * Dh) ** -0.5)),
        }
    _A_in = _A_setup()

    def _B_setup():
        B, S, D, F = 2, 1, 512, 1792
        return {
            "x": _w((lambda *s: torch.randn(*s, dtype=torch.bfloat16) * 0.05)(B, S, D)),
            "W_gate": _w((lambda *s: torch.randn(*s, dtype=torch.bfloat16) * 0.4)(D, F) * (2.0 / D) ** 0.5),
            "W_up": _w((lambda *s: torch.randn(*s, dtype=torch.bfloat16) * 0.4)(D, F) * (2.0 / D) ** 0.5),
            "W_down": _w((lambda *s: torch.randn(*s, dtype=torch.bfloat16) * 0.4)(F, D) * (1.0 / F) ** 0.5),
        }
    _B_in = _B_setup()

    return {
        "A_x": _A_in["x"],
        "A_k_cache": _A_in["k_cache"],
        "A_v_cache": _A_in["v_cache"],
        "A_wq": _A_in["wq"],
        "A_wo": _A_in["wo"],
        "B_x": _B_in["x"],
        "B_W_gate": _B_in["W_gate"],
        "B_W_up": _B_in["W_up"],
        "B_W_down": _B_in["W_down"],
    }

def reference(A_x, A_k_cache, A_v_cache, A_wq, A_wo, B_x, B_W_gate, B_W_up, B_W_down):
    def _A_ref(x, k_cache, v_cache, wq, wo):
        B, Sq, D = x.shape
        Hq, Dh = 32, 128
        Hkv = k_cache.shape[1]
        rep = Hq // Hkv
        q = (lambda x, *d: x.permute(*d))((x @ wq).reshape(B, Sq, Hq, Dh), 0, 2, 1, 3)
        k = (lambda x, n, axis: torch.repeat_interleave(x, n, dim=axis))(k_cache, rep, axis=1)
        v = (lambda x, n, axis: torch.repeat_interleave(x, n, dim=axis))(v_cache, rep, axis=1)
        scores = torch.einsum("bhqd,bhkd->bhqk", q, k) * (Dh ** -0.5)
        p = _softmax(scores, axis=-1)
        o = torch.einsum("bhqk,bhkd->bhqd", p, v)
        return (lambda x, *d: x.permute(*d))(o, 0, 2, 1, 3).reshape(B, Sq, Hq * Dh) @ wo

    def _B_ref(x, W_gate, W_up, W_down):
        gate = torch.einsum("bsd,df->bsf", x, W_gate)
        up = torch.einsum("bsd,df->bsf", x, W_up)
        gate = gate * (lambda x, dt: x.to(dt))(gate > 0, gate.dtype)
        h = gate * up
        return torch.einsum("bsf,fd->bsd", h, W_down)

    x = A_x
    x = x + _A_ref(_layernorm(x, axis=-1), A_k_cache, A_v_cache, A_wq, A_wo)
    x = x + _B_ref(_layernorm(x, axis=-1), B_W_gate, B_W_up, B_W_down)
    x = x + _A_ref(_layernorm(x, axis=-1), A_k_cache, A_v_cache, A_wq, A_wo)
    x = x + _B_ref(_layernorm(x, axis=-1), B_W_gate, B_W_up, B_W_down)
    return x
```

```asm
; @launch grid=(256,1,1) block=(512,1,1) lds=136704
.amdgcn_target "amdgcn-amd-amdhsa--gfx950"
.text
.globl interleave_layers__gqa_block_cached__glu_gated_reglu__decode_kernel
.p2align 8
.type interleave_layers__gqa_block_cached__glu_gated_reglu__decode_kernel,@function
interleave_layers__gqa_block_cached__glu_gated_reglu__decode_kernel:
    s_cmp_ge_u32 s2, 256
    s_cbranch_scc1 L_end
    s_load_dwordx16 s[4:19], s[0:1], 0
    s_load_dwordx8 s[20:27], s[0:1], 64
    v_lshrrev_b32 v1, 6, v0
    v_and_b32 v0, 63, v0
    v_readfirstlane_b32 s3, v1
    s_lshr_b32 s65, s2, 3
    s_and_b32 s64, s2, 7
    s_lshr_b32 s66, s2, 7
    s_and_b32 s67, s65, 15
    s_and_b32 s101, s65, 1
    v_lshrrev_b32 v1, 4, v0
    v_and_b32 v2, 15, v0

    v_lshlrev_b32 v21, 4, v0
    s_lshl3_add_u32 s74, s66, s64
    s_lshl4_add_u32 s74, s74, s67
    s_lshl3_add_u32 s74, s74, s3

    s_and_b32 s75, s65, 7

    s_xor_b32 s74, s74, s75
    s_lshl_b32 s74, s74, 14
    s_mov_b32 s31, 0x20000
    s_sub_u32 s30, 33554432, s74
    s_cmp_lt_u32 s3, 4
    s_cbranch_scc0 L_young
    s_lshl2_add_u32 s75, s101, s3
    s_lshl_b32 s75, s75, 19
    s_lshr_b32 s76, s65, 1
    s_lshl4_add_u32 s76, s64, s76
    s_lshl_b32 s76, s76, 6
    s_add_u32 s75, s75, s76
    s_mul_i32 s77, s3, 22528
    v_bfe_u32 v46, v0, 2, 2
    v_lshl_add_u32 v46, v1, 3, v46
    v_lshlrev_b32 v46, 13, v46
    v_and_b32 v111, 1, v1
    v_lshlrev_b32 v111, 1, v111
    v_xor_b32 v111, v111, v0
    v_and_b32 v111, 3, v111
    v_lshl_add_u32 v46, v111, 4, v46
    s_mov_b32 s43, 0x20000
    s_sub_u32 s42, 4194304, s75
    s_add_u32 m0, s77, 0
    s_waitcnt lgkmcnt(0)
    s_add_u32 s40, s10, s75
    s_addc_u32 s41, s11, 0
    buffer_load_dwordx4 v46, s[40:43], 0 offen  lds
    s_add_u32 m0, s77, 1024
    s_mov_b32 s76, 32768
    buffer_load_dwordx4 v46, s[40:43], s76 offen  lds
    s_add_u32 m0, s77, 11264
    s_mov_b32 s76, 262144
    buffer_load_dwordx4 v46, s[40:43], s76 offen  lds
    s_add_u32 m0, s77, 12288
    s_mov_b32 s76, 294912
    buffer_load_dwordx4 v46, s[40:43], s76 offen  lds
    s_add_u32 s15, s65, s3
    s_add_u32 s15, s15, s64
    s_and_b32 s15, s15, 3
    s_lshl_b32 s15, s15, 12
    s_add_u32 s28, s6, s74
    s_addc_u32 s29, s7, 0
    buffer_load_dwordx4 v[124:127], v21, s[28:31], s15 offen offset:0 nt
    buffer_load_dwordx4 v[140:143], v21, s[28:31], s15 offen offset:1024 nt
    v_lshlrev_b32 v22, 2, v0
    s_getreg_b32 s85, hwreg(HW_REG_XCC_ID, 0, 4)
    s_lshl_b32 s68, s64, 5
    s_add_u32 s68, s68, s65
    s_xor_b32 s80, s15, 4096
    s_xor_b32 s81, s15, 8192
    s_xor_b32 s82, s15, 12288
    s_add_u32 s32, s8, s74
    s_addc_u32 s33, s9, 0
    s_mov_b32 s34, s30
    s_mov_b32 s35, 0x20000
    s_mov_b32 s36, s26
    s_mov_b32 s37, s27
    s_mov_b32 s38, 4194304
    s_mov_b32 s39, 0x20000
    s_lshr_b32 s75, s64, 2
    s_xor_b32 s75, s75, 0
    s_lshl1_add_u32 s79, s66, s75
    s_lshl4_add_u32 s79, s79, s67
    s_and_b32 s75, s64, 3
    s_lshl2_add_u32 s79, s79, s75
    v_lshlrev_b32 v104, 4, v0
    s_cmp_eq_u32 s3, 0
    s_cbranch_scc0 L_sm1
    s_mov_b32 s44, s4
    s_mov_b32 s45, s5
    s_mov_b32 s46, 2048
    s_mov_b32 s47, 0x20000
    s_mov_b32 m0, 106496
    s_nop 0
    buffer_load_dwordx4 v104, s[44:47], 0 offen lds
    buffer_load_dwordx4 v104, s[44:47], 0 offen offset:1024 lds
    s_branch L_sm9
L_sm1:
    s_cmp_eq_u32 s3, 3
    s_cbranch_scc0 L_sm2
    buffer_load_dword v47, off, s[36:39], 0 offset:4 sc1
    s_branch L_sm9
L_sm2:
    v_mov_b32 v112, -1
    v_mov_b32 v113, -1
    v_mov_b32 v114, -1
    v_mov_b32 v115, -1
    s_lshl_b32 s76, s68, 10
    s_add_u32 s76, s76, 458752
    v_lshl_add_u32 v116, v0, 4, s76
    v_mov_b32 v106, s68
    v_mov_b32 v107, s79
    v_cmp_lt_u32 vcc, 1, v1
    s_nop 1
    v_cndmask_b32 v106, v106, v107, vcc
    v_lshrrev_b32 v107, 3, v0
    v_lshlrev_b32 v108, 15, v107
    v_lshl_add_u32 v117, v106, 7, v108
    v_and_b32 v108, 7, v0
    v_lshl_add_u32 v117, v108, 4, v117
    v_add_u32 v117, 65536, v117
    s_lshl_b32 s76, s68, 7
    s_add_u32 s76, s76, 327680
    v_lshlrev_b32 v107, 22, v107
    v_lshl_add_u32 v118, v108, 4, v107
    v_add_u32 v118, s76, v118
    s_mov_b32 s77, 327680
    s_cmp_eq_u32 s3, 1
    s_cbranch_scc1 L_sm3
    v_mov_b32 v116, v117
    s_mov_b32 exec_lo, 0x00ff00ff
    s_mov_b32 exec_hi, 0x00ff00ff
L_sm3:
    buffer_store_dwordx4 v[112:115], v116, s[36:39], 0 offen sc1
    s_mov_b64 exec, -1
L_sm9:
    buffer_load_dwordx4 v[156:159], v21, s[28:31], s15 offen offset:2048 nt
    buffer_load_dwordx4 v[172:175], v21, s[28:31], s15 offen offset:3072 nt
    buffer_load_dwordx4 v[128:131], v21, s[28:31], s80 offen offset:0 nt
    buffer_load_dwordx4 v[144:147], v21, s[28:31], s80 offen offset:1024 nt
    buffer_load_dwordx4 v[160:163], v21, s[28:31], s80 offen offset:2048 nt
    buffer_load_dwordx4 v[176:179], v21, s[28:31], s80 offen offset:3072 nt
    buffer_load_dwordx4 v[132:135], v21, s[28:31], s81 offen offset:0 nt
    buffer_load_dwordx4 v[148:151], v21, s[28:31], s81 offen offset:1024 nt
    buffer_load_dwordx4 v[164:167], v21, s[28:31], s81 offen offset:2048 nt
    buffer_load_dwordx4 v[180:183], v21, s[28:31], s81 offen offset:3072 nt
    s_waitcnt vmcnt(10)
    s_cmp_eq_u32 s3, 3
    s_cbranch_scc0 L_b1
    v_mov_b32 v107, 110596
    v_add_u32 v47, 2654435760, v47
    ds_write_b32 v107, v47
    s_waitcnt lgkmcnt(0)
L_b1:
    s_barrier
    buffer_load_dwordx4 v[136:139], v21, s[28:31], s82 offen offset:0 nt
    buffer_load_dwordx4 v[152:155], v21, s[28:31], s82 offen offset:1024 nt
    buffer_load_dwordx4 v[168:171], v21, s[28:31], s82 offen offset:2048 nt
    buffer_load_dwordx4 v[184:187], v21, s[28:31], s82 offen offset:3072 nt
L_vloads:
    buffer_load_dword v190, v22, s[32:35], s15 offen offset:0 nt
    buffer_load_dword v192, v22, s[32:35], s15 offen offset:256 nt
    buffer_load_dword v191, v22, s[32:35], s15 offen offset:512 nt
    buffer_load_dword v193, v22, s[32:35], s15 offen offset:768 nt
    buffer_load_dword v194, v22, s[32:35], s15 offen offset:1024 nt
    buffer_load_dword v196, v22, s[32:35], s15 offen offset:1280 nt
    buffer_load_dword v195, v22, s[32:35], s15 offen offset:1536 nt
    buffer_load_dword v197, v22, s[32:35], s15 offen offset:1792 nt
    buffer_load_dword v198, v22, s[32:35], s15 offen offset:2048 nt
    buffer_load_dword v200, v22, s[32:35], s15 offen offset:2304 nt
    buffer_load_dword v199, v22, s[32:35], s15 offen offset:2560 nt
    buffer_load_dword v201, v22, s[32:35], s15 offen offset:2816 nt
    buffer_load_dword v202, v22, s[32:35], s15 offen offset:3072 nt
    buffer_load_dword v204, v22, s[32:35], s15 offen offset:3328 nt
    buffer_load_dword v203, v22, s[32:35], s15 offen offset:3584 nt
    buffer_load_dword v205, v22, s[32:35], s15 offen offset:3840 nt
    buffer_load_dword v206, v22, s[32:35], s80 offen offset:0 nt
    buffer_load_dword v208, v22, s[32:35], s80 offen offset:256 nt
    buffer_load_dword v207, v22, s[32:35], s80 offen offset:512 nt
    buffer_load_dword v209, v22, s[32:35], s80 offen offset:768 nt
    buffer_load_dword v210, v22, s[32:35], s80 offen offset:1024 nt
    buffer_load_dword v212, v22, s[32:35], s80 offen offset:1280 nt
    buffer_load_dword v211, v22, s[32:35], s80 offen offset:1536 nt
    buffer_load_dword v213, v22, s[32:35], s80 offen offset:1792 nt
    buffer_load_dword v214, v22, s[32:35], s80 offen offset:2048 nt
    buffer_load_dword v216, v22, s[32:35], s80 offen offset:2304 nt
    buffer_load_dword v215, v22, s[32:35], s80 offen offset:2560 nt
    buffer_load_dword v217, v22, s[32:35], s80 offen offset:2816 nt
    buffer_load_dword v218, v22, s[32:35], s80 offen offset:3072 nt
    buffer_load_dword v220, v22, s[32:35], s80 offen offset:3328 nt
    buffer_load_dword v219, v22, s[32:35], s80 offen offset:3584 nt
    buffer_load_dword v221, v22, s[32:35], s80 offen offset:3840 nt
    buffer_load_dword v222, v22, s[32:35], s81 offen offset:0 nt
    buffer_load_dword v224, v22, s[32:35], s81 offen offset:256 nt
    buffer_load_dword v223, v22, s[32:35], s81 offen offset:512 nt
    buffer_load_dword v225, v22, s[32:35], s81 offen offset:768 nt
    buffer_load_dword v226, v22, s[32:35], s81 offen offset:1024 nt
    buffer_load_dword v228, v22, s[32:35], s81 offen offset:1280 nt
    buffer_load_dword v227, v22, s[32:35], s81 offen offset:1536 nt
    buffer_load_dword v229, v22, s[32:35], s81 offen offset:1792 nt
    buffer_load_dword v230, v22, s[32:35], s81 offen offset:2048 nt
    buffer_load_dword v232, v22, s[32:35], s81 offen offset:2304 nt
    buffer_load_dword v231, v22, s[32:35], s81 offen offset:2560 nt
    buffer_load_dword v233, v22, s[32:35], s81 offen offset:2816 nt
    buffer_load_dword v234, v22, s[32:35], s81 offen offset:3072 nt
    buffer_load_dword v236, v22, s[32:35], s81 offen offset:3328 nt
    buffer_load_dword v235, v22, s[32:35], s81 offen offset:3584 nt
    buffer_load_dword v237, v22, s[32:35], s81 offen offset:3840 nt
    s_waitcnt vmcnt(48)
    s_cmp_lt_u32 s3, 4
    s_cbranch_scc0 L_mid
L_vrest:
    buffer_load_dword v238, v22, s[32:35], s82 offen offset:0 nt
    buffer_load_dword v240, v22, s[32:35], s82 offen offset:256 nt
    buffer_load_dword v239, v22, s[32:35], s82 offen offset:512 nt
    buffer_load_dword v241, v22, s[32:35], s82 offen offset:768 nt
    buffer_load_dword v242, v22, s[32:35], s82 offen offset:1024 nt
    buffer_load_dword v244, v22, s[32:35], s82 offen offset:1280 nt
    buffer_load_dword v243, v22, s[32:35], s82 offen offset:1536 nt
    buffer_load_dword v245, v22, s[32:35], s82 offen offset:1792 nt
    buffer_load_dword v246, v22, s[32:35], s82 offen offset:2048 nt
    buffer_load_dword v248, v22, s[32:35], s82 offen offset:2304 nt
    buffer_load_dword v247, v22, s[32:35], s82 offen offset:2560 nt
    buffer_load_dword v249, v22, s[32:35], s82 offen offset:2816 nt
    buffer_load_dword v250, v22, s[32:35], s82 offen offset:3072 nt
    buffer_load_dword v252, v22, s[32:35], s82 offen offset:3328 nt
    buffer_load_dword v251, v22, s[32:35], s82 offen offset:3584 nt
    buffer_load_dword v253, v22, s[32:35], s82 offen offset:3840 nt
    s_cmp_lt_u32 s3, 4
    s_cbranch_scc0 L_joined
    s_branch L_setup
L_young:
    s_getpc_b64 s[94:95]
L_pc:
    s_lshl2_add_u32 s76, s65, s3
    s_sub_u32 s76, s76, 4
    s_lshl_b32 s76, s76, 7
    s_min_u32 s76, s76, L_codeend-L_pc-64
    v_lshl_add_u32 v106, v0, 6, s76
    s_mov_b64 exec, 3
    global_load_dword v122, v106, s[94:95]
    s_mov_b64 exec, -1
    v_mov_b32 v107, 110592
    v_mov_b32 v108, 0
    ds_write_b32 v107, v108
    s_waitcnt lgkmcnt(0)
    s_add_u32 s28, s6, s74
    s_addc_u32 s29, s7, 0
    s_add_u32 s15, s65, s3
    s_add_u32 s15, s15, s64
    s_and_b32 s15, s15, 3
    s_lshl_b32 s15, s15, 12
    v_lshlrev_b32 v22, 2, v0
    s_getreg_b32 s85, hwreg(HW_REG_XCC_ID, 0, 4)
    s_lshl_b32 s68, s64, 5
    s_add_u32 s68, s68, s65
    s_xor_b32 s80, s15, 4096
    s_xor_b32 s81, s15, 8192
    s_xor_b32 s82, s15, 12288
    s_add_u32 s32, s8, s74
    s_addc_u32 s33, s9, 0
    s_mov_b32 s34, s30
    s_mov_b32 s35, 0x20000
    s_mov_b32 s36, s26
    s_mov_b32 s37, s27
    s_mov_b32 s38, 4194304
    s_mov_b32 s39, 0x20000
    s_lshr_b32 s75, s64, 2
    s_xor_b32 s75, s75, 0
    s_lshl1_add_u32 s79, s66, s75
    s_lshl4_add_u32 s79, s79, s67
    s_and_b32 s75, s64, 3
    s_lshl2_add_u32 s79, s79, s75
    s_cmp_eq_u32 s3, 7
    s_cbranch_scc1 L_w7a

    s_branch L_setup
L_w7a:
    s_setprio 3
L_setup:
    v_bfe_u32 v109, v0, 3, 2
    v_lshlrev_b32 v39, 3, v109
    v_lshrrev_b32 v109, 5, v0
    v_lshl_add_u32 v39, v109, 2, v39
    v_bfe_u32 v109, v0, 1, 2
    v_add_u32 v39, v39, v109
    v_and_b32 v40, 1, v0
    v_lshlrev_b32 v40, 4, v40
    s_mul_i32 s78, s3, 11264
    s_mov_b32 s86, 0x00030003
    s_mov_b32 s87, 0x00030003
    s_mov_b32 s88, 0x01010101
    s_mov_b32 s89, 0x01010101
    s_mov_b32 s90, 0x01010101
    s_mov_b32 s91, 0
    s_mov_b32 s92, 0x00001111
    s_mov_b32 s93, 0x00001111
    s_mov_b32 s96, 0x11111111
    s_mov_b32 s97, 0
    s_mov_b32 s83, 0x05040100
    s_mov_b32 s84, 0x07060302
    s_mov_b32 s71, 8000000
    s_mov_b32 s72, 0
    s_mov_b32 s73, 0
    s_mov_b32 s69, 0
    s_mov_b32 s70, 0
    v_lshrrev_b32 v106, 1, v1
    v_and_b32 v107, 1, v1
    v_lshl_add_u32 v3, v0, 3, s78
    s_lshl_b32 s76, s3, 8
    s_add_u32 s76, s76, 111104
    v_add_u32 v9, s76, v22
    v_add_u32 v7, 111104, v22
    v_lshlrev_b32 v11, 6, v2
    v_lshl_add_u32 v11, v1, 4, v11
    v_add_u32 v11, s76, v11
    v_lshlrev_b32 v109, 4, v0
    v_add_u32 v8, s76, v109
    v_add_u32 v109, 123392, v109
    v_add_u32 v10, 1920, v11
    v_cmp_eq_u32 vcc, 2, v2
    s_nop 1
    v_cndmask_b32 v10, v109, v10, vcc
    v_cmp_gt_u32 vcc, 2, v2
    s_nop 1
    v_cndmask_b32 v10, v10, v11, vcc
    v_cndmask_b32 v11, v109, v11, vcc
    v_cmp_gt_u32 vcc, 2, v0
    s_nop 1
    v_cndmask_b32 v8, v109, v8, vcc
    v_mov_b32 v42, 0x3b000000
    v_mov_b32 v41, 0x3e0293ee
    v_mov_b32 v43, 0
    v_mov_b32 v44, 0
    v_mov_b32 v84, 0
    ds_write_b32 v7, v43 offset:12032
    v_lshrrev_b32 v108, 2, v2
    s_and_b32 s77, s68, 0xf0
    s_lshl_b32 s77, s77, 7
    s_add_u32 s77, s77, 327680
    v_lshl_add_u32 v23, v0, 4, s77
    s_lshl_b32 s76, s64, 12
    s_lshl_b32 s77, s3, 8
    s_add_u32 s76, s76, s77
    s_add_u32 s76, s76, 131072
    v_lshl_add_u32 v27, v106, 7, s76
    v_lshl_add_u32 v27, v2, 5, v27
    v_lshl_add_u32 v27, v107, 4, v27
    s_and_b32 s76, s68, 0xf0
    s_lshl_b32 s77, s3, 1
    s_add_u32 s77, s77, s76
    s_lshl_b32 s77, s77, 10
    s_add_u32 s77, s77, 458752
    v_lshl_add_u32 v24, v0, 4, s77
    v_lshl_add_u32 v25, v1, 2, v2
    v_and_b32 v25, 15, v25
    s_lshr_b32 s77, s3, 1
    s_add_u32 s77, s77, s76
    s_lshl_b32 s77, s77, 7
    s_add_u32 s77, s77, 65536
    v_lshl_add_u32 v25, v25, 3, s77
    v_xor_b32 v105, 0, v106
    v_lshlrev_b32 v105, 13, v105
    v_lshrrev_b32 v26, 3, v2
    v_lshl_add_u32 v26, v26, 9, v105
    v_lshl_add_u32 v26, v107, 14, v26
    v_and_b32 v109, 7, v2
    v_lshl_add_u32 v26, v109, 4, v26
    s_lshl_b32 s77, s3, 10
    s_add_u32 s77, s77, 196608
    v_add_u32 v26, s77, v26
    v_bfe_u32 v28, v0, 3, 2
    v_lshl_add_u32 v28, v28, 9, v105
    v_lshl_add_u32 v28, v109, 4, v28
    s_lshr_b32 s76, s3, 2
    s_lshl_b32 s76, s76, 14
    s_and_b32 s77, s3, 3
    s_lshl_b32 s77, s77, 11
    s_add_u32 s77, s77, s76
    s_add_u32 s77, s77, 262144
    v_add_u32 v28, s77, v28
    v_lshl_add_u32 v109, v2, 2, v105
    s_lshr_b32 s76, s65, 1
    s_lshl_b32 s76, s76, 9
    s_lshl_b32 s77, s101, 6
    s_add_u32 s76, s76, s77
    s_add_u32 s76, s76, 196608
    v_lshl_add_u32 v29, v107, 14, v109
    v_add_u32 v29, s76, v29
    s_lshl_b32 s76, s66, 14
    s_lshl_b32 s77, s67, 9
    s_add_u32 s76, s76, s77
    s_add_u32 s76, s76, 262144
    v_lshl_add_u32 v30, v107, 6, v109
    v_add_u32 v30, s76, v30
    s_lshl_b32 s76, s65, 5
    v_lshlrev_b32 v38, 10, v107
    v_lshl_add_u32 v38, v2, 1, v38
    v_add_u32 v38, s76, v38
    s_and_b32 s75, s68, 0xf0
    s_lshl_b32 s76, s3, 2
    s_add_u32 s76, s76, s75
    s_lshl_b32 s76, s76, 10
    s_lshl_b32 s77, s67, 4
    s_add_u32 s76, s76, s77
    s_add_u32 s76, s76, 458752
    v_lshrrev_b32 v32, 2, v0
    v_lshl_add_u32 v32, v32, 8, s76
    v_and_b32 v109, 3, v0
    v_lshl_add_u32 v32, v109, 2, v32
    s_add_u32 s76, s75, s3
    s_lshl_b32 s76, s76, 7
    s_lshl_b32 s77, s67, 3
    s_add_u32 s76, s76, s77
    s_add_u32 s76, s76, 65536
    v_mov_b32 v33, s76
    s_bfe_u32 s76, s65, 0x20001
    s_lshl_b32 s76, s76, 2
    s_lshr_b32 s77, s65, 3
    s_add_u32 s76, s76, s77
    s_lshl_b32 s76, s76, 4
    s_lshl_b32 s77, s64, 12
    s_add_u32 s76, s76, s77
    s_lshl_b32 s77, s101, 10
    s_add_u32 s76, s76, s77
    s_add_u32 s76, s76, 327680
    v_lshl_add_u32 v37, v107, 11, s76
    v_lshl_add_u32 v37, v106, 9, v37
    v_lshrrev_b32 v109, 3, v2
    v_lshl_add_u32 v37, v109, 8, v37
    s_lshl_b32 s76, s68, 7
    v_lshl_add_u32 v36, v0, 1, s76
    s_lshl_b32 s76, s79, 7
    s_add_u32 s77, s76, 262144
    v_add_u32 v35, s77, v22
    s_add_u32 s76, s76, 196608
    v_lshlrev_b32 v34, 2, v2
    v_lshl_add_u32 v34, v106, 6, v34
    v_add_u32 v34, s76, v34
    v_lshrrev_b32 v4, 2, v0
    v_lshlrev_b32 v4, 6, v4
    v_and_b32 v5, 3, v0
    v_lshl_add_u32 v4, v5, 3, v4
    v_lshl_add_u32 v4, v107, 5, v4
    s_and_b32 s76, s3, 3
    s_mul_i32 s76, s76, 22528
    v_add_u32 v6, s76, v4
    v_add_u32 v4, s78, v4
    v_xor_b32 v5, 32, v4
    s_lshl_b32 s76, s3, 11
    s_add_u32 s76, s76, 90112
    v_lshl_add_u32 v14, v0, 3, s76
    v_add_u32 v15, 1024, v14
    s_lshl_b32 s76, s3, 9
    s_add_u32 s76, s76, 90112
    v_lshl_add_u32 v16, v0, 3, s76
    s_lshl_b32 s76, s3, 3
    s_add_u32 s76, s76, 110848
    v_and_b32 v17, 3, v0
    v_lshl_add_u32 v17, v17, 6, s76
    s_lshl_b32 s76, s3, 6
    s_add_u32 s76, s76, 110848
    v_and_b32 v18, 7, v0
    v_lshl_add_u32 v18, v18, 3, s76
    v_lshlrev_b32 v12, 2, v2
    v_lshl_add_u32 v12, v106, 7, v12
    v_add_u32 v12, 113152, v12
    s_lshl_b32 s76, s3, 7
    s_add_u32 s76, s76, 106496
    v_lshl_add_u32 v19, v107, 10, s76
    v_lshl_add_u32 v19, v2, 3, v19
    v_lshl_add_u32 v19, v106, 2, v19
    v_min_u32 v20, 2, v2
    v_lshl_add_u32 v20, v20, 10, s76
    v_lshl_add_u32 v20, v1, 4, v20
    v_lshlrev_b32 v109, 2, v107
    v_cmp_gt_u32 vcc, 8, v2
    s_nop 1
    v_cndmask_b32 v109, 8, v109, vcc
    v_and_b32 v13, 7, v0
    v_lshlrev_b32 v13, 8, v13
    v_lshl_add_u32 v13, v107, 4, v13
    v_add_u32 v13, v13, v109
    v_add_u32 v13, 113344, v13
    v_lshlrev_b32 v109, 1, v2
    v_lshl_add_u32 v109, v106, 5, v109
    s_lshl_b32 s76, s66, 10
    s_lshl_b32 s77, s67, 6
    s_add_u32 s76, s76, s77
    s_add_u32 s76, s76, 106496
    v_add_u32 v31, s76, v109
    s_lshl_b32 s75, s64, 19
    s_and_b32 s76, s3, 3
    s_lshl_b32 s76, s76, 16
    s_add_u32 s75, s75, s76
    s_lshl_b32 s76, s67, 6
    s_add_u32 s75, s75, s76
    s_add_u32 s48, s12, s75
    s_addc_u32 s49, s13, 0
    s_sub_u32 s50, 4194304, s75
    s_mov_b32 s51, 0x20000
    s_mov_b32 s60, s22
    s_mov_b32 s61, s23
    s_mov_b32 s62, 2048
    s_mov_b32 s63, 0x20000
    s_mul_i32 s75, s64, 14
    s_min_u32 s76, s65, 13
    s_add_u32 s75, s75, s76
    s_lshl_b32 s75, s75, 5
    s_mul_i32 s76, s3, 229376
    s_add_u32 s75, s75, s76
    s_add_u32 s52, s16, s75
    s_addc_u32 s53, s17, 0
    s_sub_u32 s54, 1835008, s75
    s_mov_b32 s55, 0x20000
    s_add_u32 s56, s18, s75
    s_addc_u32 s57, s19, 0
    s_sub_u32 s58, 1835008, s75
    s_mov_b32 s59, 0x20000
    s_mul_i32 s75, s64, 7
    s_min_u32 s76, s3, 6
    s_add_u32 s75, s75, s76
    s_lshl_b32 s75, s75, 15
    s_lshl_b32 s76, s65, 5
    s_add_u32 s75, s75, s76
    s_add_u32 s4, s20, s75
    s_addc_u32 s5, s21, 0
    s_sub_u32 s6, 1835008, s75
    s_mov_b32 s7, 0x20000
    s_cmp_lt_u32 s3, 4
    s_cbranch_scc1 L_joined
    s_cmp_eq_u32 s3, 7
    s_cbranch_scc0 L_young2
    v_mov_b32 v88, 0x3f803f80
    v_mov_b32 v89, 0x3f803f80
    v_mov_b32 v90, 0x3f803f80
    v_mov_b32 v91, 0x3f803f80
    v_lshlrev_b32 v104, 4, v0
    v_add_u32 v104, 108544, v104
    ds_write_b128 v104, v[88:91]
    v_subrev_u32 v104, s78, v4
    v_xor_b32 v105, 32, v104
    s_lshl_b32 s76, s101, 9
    v_subrev_u32 v106, 896, v20
    v_add_u32 v106, s76, v106
    v_xor_b32 v109, 512, v106
    v_mov_b32 v107, 110596
    s_waitcnt lgkmcnt(0)
    s_barrier
    ds_read_b32 v47, v107
    ds_read_b64_tr_b16 v[48:49], v104 offset:0
    ds_read_b64_tr_b16 v[50:51], v104 offset:1024
    ds_read_b64_tr_b16 v[52:53], v105 offset:0
    ds_read_b64_tr_b16 v[54:55], v105 offset:1024
    ds_read_b128 v[64:67], v106 offset:0
    ds_read_b128 v[68:71], v109 offset:0
    ds_read_b64_tr_b16 v[56:57], v104 offset:11264
    ds_read_b64_tr_b16 v[58:59], v104 offset:12288
    ds_read_b64_tr_b16 v[60:61], v105 offset:11264
    ds_read_b64_tr_b16 v[62:63], v105 offset:12288
    ds_read_b128 v[72:75], v106 offset:64
    ds_read_b128 v[76:79], v109 offset:64
    s_waitcnt lgkmcnt(6)
    v_mfma_f32_16x16x32_bf16 v[88:91], v[48:51], v[64:67], 0
    v_mfma_f32_16x16x32_bf16 v[92:95], v[64:67], v[64:67], 0
    v_mfma_f32_16x16x32_bf16 v[100:103], v[52:55], v[64:67], 0
    v_mfma_f32_16x16x32_bf16 v[92:95], v[68:71], v[68:71], v[92:95]
    ds_read_b64_tr_b16 v[48:49], v104 offset:22528
    ds_read_b64_tr_b16 v[50:51], v104 offset:23552
    ds_read_b64_tr_b16 v[52:53], v105 offset:22528
    ds_read_b64_tr_b16 v[54:55], v105 offset:23552
    ds_read_b128 v[64:67], v106 offset:128
    ds_read_b128 v[68:71], v109 offset:128
    s_waitcnt lgkmcnt(6)
    v_mfma_f32_16x16x32_bf16 v[88:91], v[56:59], v[72:75], v[88:91]
    v_mfma_f32_16x16x32_bf16 v[92:95], v[72:75], v[72:75], v[92:95]
    v_mfma_f32_16x16x32_bf16 v[100:103], v[60:63], v[72:75], v[100:103]
    v_mfma_f32_16x16x32_bf16 v[92:95], v[76:79], v[76:79], v[92:95]
    ds_read_b64_tr_b16 v[56:57], v104 offset:33792
    ds_read_b64_tr_b16 v[58:59], v104 offset:34816
    ds_read_b64_tr_b16 v[60:61], v105 offset:33792
    ds_read_b64_tr_b16 v[62:63], v105 offset:34816
    ds_read_b128 v[72:75], v106 offset:192
    ds_read_b128 v[76:79], v109 offset:192
    s_waitcnt lgkmcnt(6)
    v_mfma_f32_16x16x32_bf16 v[88:91], v[48:51], v[64:67], v[88:91]
    v_mfma_f32_16x16x32_bf16 v[92:95], v[64:67], v[64:67], v[92:95]
    v_mfma_f32_16x16x32_bf16 v[100:103], v[52:55], v[64:67], v[100:103]
    v_mfma_f32_16x16x32_bf16 v[92:95], v[68:71], v[68:71], v[92:95]
    v_add_u32 v104, 45056, v104
    v_add_u32 v105, 45056, v105
    ds_read_b64_tr_b16 v[48:49], v104 offset:0
    ds_read_b64_tr_b16 v[50:51], v104 offset:1024
    ds_read_b64_tr_b16 v[52:53], v105 offset:0
    ds_read_b64_tr_b16 v[54:55], v105 offset:1024
    ds_read_b128 v[64:67], v106 offset:256
    ds_read_b128 v[68:71], v109 offset:256
    s_waitcnt lgkmcnt(6)
    v_mfma_f32_16x16x32_bf16 v[88:91], v[56:59], v[72:75], v[88:91]
    v_mfma_f32_16x16x32_bf16 v[92:95], v[72:75], v[72:75], v[92:95]
    v_mfma_f32_16x16x32_bf16 v[100:103], v[60:63], v[72:75], v[100:103]
    v_mfma_f32_16x16x32_bf16 v[92:95], v[76:79], v[76:79], v[92:95]
    ds_read_b64_tr_b16 v[56:57], v104 offset:11264
    ds_read_b64_tr_b16 v[58:59], v104 offset:12288
    ds_read_b64_tr_b16 v[60:61], v105 offset:11264
    ds_read_b64_tr_b16 v[62:63], v105 offset:12288
    ds_read_b128 v[72:75], v106 offset:320
    ds_read_b128 v[76:79], v109 offset:320
    s_waitcnt lgkmcnt(6)
    v_mfma_f32_16x16x32_bf16 v[88:91], v[48:51], v[64:67], v[88:91]
    v_mfma_f32_16x16x32_bf16 v[92:95], v[64:67], v[64:67], v[92:95]
    v_mfma_f32_16x16x32_bf16 v[100:103], v[52:55], v[64:67], v[100:103]
    v_mfma_f32_16x16x32_bf16 v[92:95], v[68:71], v[68:71], v[92:95]
    ds_read_b64_tr_b16 v[48:49], v104 offset:22528
    ds_read_b64_tr_b16 v[50:51], v104 offset:23552
    ds_read_b64_tr_b16 v[52:53], v105 offset:22528
    ds_read_b64_tr_b16 v[54:55], v105 offset:23552
    ds_read_b128 v[64:67], v106 offset:384
    ds_read_b128 v[68:71], v109 offset:384
    s_waitcnt lgkmcnt(6)
    v_mfma_f32_16x16x32_bf16 v[88:91], v[56:59], v[72:75], v[88:91]
    v_mfma_f32_16x16x32_bf16 v[92:95], v[72:75], v[72:75], v[92:95]
    v_mfma_f32_16x16x32_bf16 v[100:103], v[60:63], v[72:75], v[100:103]
    v_mfma_f32_16x16x32_bf16 v[92:95], v[76:79], v[76:79], v[92:95]
    ds_read_b64_tr_b16 v[56:57], v104 offset:33792
    ds_read_b64_tr_b16 v[58:59], v104 offset:34816
    ds_read_b64_tr_b16 v[60:61], v105 offset:33792
    ds_read_b64_tr_b16 v[62:63], v105 offset:34816
    ds_read_b128 v[72:75], v106 offset:448
    ds_read_b128 v[76:79], v109 offset:448
    s_waitcnt lgkmcnt(6)
    v_mfma_f32_16x16x32_bf16 v[88:91], v[48:51], v[64:67], v[88:91]
    v_mfma_f32_16x16x32_bf16 v[92:95], v[64:67], v[64:67], v[92:95]
    v_mfma_f32_16x16x32_bf16 v[100:103], v[52:55], v[64:67], v[100:103]
    v_mfma_f32_16x16x32_bf16 v[92:95], v[68:71], v[68:71], v[92:95]
    s_waitcnt lgkmcnt(0)
    v_mfma_f32_16x16x32_bf16 v[88:91], v[56:59], v[72:75], v[88:91]
    v_mfma_f32_16x16x32_bf16 v[92:95], v[72:75], v[72:75], v[92:95]
    v_mfma_f32_16x16x32_bf16 v[100:103], v[60:63], v[72:75], v[100:103]
    v_mfma_f32_16x16x32_bf16 v[92:95], v[76:79], v[76:79], v[92:95]
    v_cmp_eq_u32 vcc, 0, v2
    s_nop 6
    v_readlane_b32 s74, v92, 0
    v_readlane_b32 s75, v93, 1
    v_readlane_b32 s76, v94, 0
    v_readlane_b32 s77, v94, 1
    v_mov_b32 v96, s74
    v_mov_b32 v107, s75
    v_mov_b32 v97, s76
    v_mov_b32 v108, s77
    v_cndmask_b32 v96, v107, v96, vcc
    v_cndmask_b32 v97, v108, v97, vcc
    v_mul_f32 v98, 0x3b000000, v97
    v_mul_f32 v96, 0x3b000000, v96
    v_fma_f32 v96, -v98, v98, v96
    v_max_f32 v96, 0, v96
    v_add_f32 v96, 0x3727c5ac, v96
    v_rsq_f32 v99, v96
    s_lshl_b32 s76, s64, 13
    s_lshl_b32 s77, s101, 11
    s_add_u32 s76, s76, s77
    s_lshr_b32 s77, s65, 1
    s_lshl_b32 s77, s77, 7
    s_add_u32 s76, s76, s77
    s_add_u32 s76, s76, 360448
    v_lshlrev_b32 v107, 7, v2
    v_lshl_add_u32 v107, v1, 4, v107
    v_add_u32 v107, 104448, v107
    v_lshlrev_b32 v108, 4, v0
    v_add_u32 v105, 104448, v108
    v_lshrrev_b32 v104, 3, v0
    v_mul_u32_u24 v104, 3968, v104
    v_add_u32 v104, v104, v108
    v_mul_f32_dpp v92, v88, v98 quad_perm:[2,2,2,2] row_mask:0xf bank_mask:0xf
    v_mul_f32_dpp v93, v89, v98 quad_perm:[2,2,2,2] row_mask:0xf bank_mask:0xf
    v_mul_f32_dpp v94, v90, v98 quad_perm:[2,2,2,2] row_mask:0xf bank_mask:0xf
    v_mul_f32_dpp v95, v91, v98 quad_perm:[2,2,2,2] row_mask:0xf bank_mask:0xf
    v_sub_f32 v88, v88, v92
    v_mul_f32 v88, v88, v99
    v_sub_f32 v89, v89, v93
    v_mul_f32 v89, v89, v99
    v_sub_f32 v90, v90, v94
    v_mul_f32 v90, v90, v99
    v_sub_f32 v91, v91, v95
    v_mul_f32 v91, v91, v99
    v_cvt_pk_bf16_f32 v64, v88, v89
    v_cvt_pk_bf16_f32 v66, v90, v91
    v_add_u32 v65, s85, v47
    v_add_u32 v67, s85, v47
    v_mul_f32_dpp v92, v100, v98 quad_perm:[2,2,2,2] row_mask:0xf bank_mask:0xf
    v_mul_f32_dpp v93, v101, v98 quad_perm:[2,2,2,2] row_mask:0xf bank_mask:0xf
    v_mul_f32_dpp v94, v102, v98 quad_perm:[2,2,2,2] row_mask:0xf bank_mask:0xf
    v_mul_f32_dpp v95, v103, v98 quad_perm:[2,2,2,2] row_mask:0xf bank_mask:0xf
    v_sub_f32 v100, v100, v92
    v_mul_f32 v100, v100, v99
    v_sub_f32 v101, v101, v93
    v_mul_f32 v101, v101, v99
    v_sub_f32 v102, v102, v94
    v_mul_f32 v102, v102, v99
    v_sub_f32 v103, v103, v95
    v_mul_f32 v103, v103, v99
    v_cvt_pk_bf16_f32 v68, v100, v101
    v_cvt_pk_bf16_f32 v70, v102, v103
    v_add_u32 v69, s85, v47
    v_add_u32 v71, s85, v47
    ds_write_b128 v107, v[64:67]
    ds_write_b128 v107, v[68:71] offset:64
    ds_read_b128 v[72:75], v105
    s_mov_b64 exec, 0xffff
    s_waitcnt lgkmcnt(0)
    buffer_store_dwordx4 v[72:75], v104, s[36:39], s76 offen
    v_add_u32 v84, s76, v104
    v_mov_b32 v80, v72
    v_mov_b32 v81, v73
    v_mov_b32 v82, v74
    v_mov_b32 v83, v75
    s_mov_b64 exec, -1
    s_setprio 0
    s_branch L_young3
L_young2:
    s_barrier
L_young3:
    buffer_load_dwordx4 v[124:127], v21, s[28:31], s15 offen offset:0 nt
    buffer_load_dwordx4 v[140:143], v21, s[28:31], s15 offen offset:1024 nt
    buffer_load_dwordx4 v[156:159], v21, s[28:31], s15 offen offset:2048 nt
    buffer_load_dwordx4 v[172:175], v21, s[28:31], s15 offen offset:3072 nt
    buffer_load_dwordx4 v[128:131], v21, s[28:31], s80 offen offset:0 nt
    buffer_load_dwordx4 v[144:147], v21, s[28:31], s80 offen offset:1024 nt
    buffer_load_dwordx4 v[160:163], v21, s[28:31], s80 offen offset:2048 nt
    buffer_load_dwordx4 v[176:179], v21, s[28:31], s80 offen offset:3072 nt
    buffer_load_dwordx4 v[132:135], v21, s[28:31], s81 offen offset:0 nt
    buffer_load_dwordx4 v[148:151], v21, s[28:31], s81 offen offset:1024 nt
    buffer_load_dwordx4 v[164:167], v21, s[28:31], s81 offen offset:2048 nt
    buffer_load_dwordx4 v[180:183], v21, s[28:31], s81 offen offset:3072 nt
    buffer_load_dwordx4 v[136:139], v21, s[28:31], s82 offen offset:0 nt
    buffer_load_dwordx4 v[152:155], v21, s[28:31], s82 offen offset:1024 nt
    buffer_load_dwordx4 v[168:171], v21, s[28:31], s82 offen offset:2048 nt
    buffer_load_dwordx4 v[184:187], v21, s[28:31], s82 offen offset:3072 nt
    s_branch L_vloads
L_joined:
    s_cmp_eq_u32 s3, 1
    s_cbranch_scc0 L_h2
    v_mov_b32 v109, 110596
    ds_read_b32 v47, v109
    s_lshr_b32 s76, s68, 4
    s_lshl_b32 s76, s76, 12
    s_add_u32 s76, s76, 360448
    v_lshl_add_u32 v109, v0, 4, s76
L_hq:
    buffer_load_dwordx4 v[88:91], v109, s[36:39], 0 offen offset:0 sc1
    buffer_load_dwordx4 v[92:95], v109, s[36:39], 0 offen offset:1024 sc1
    buffer_load_dwordx4 v[96:99], v109, s[36:39], 0 offen offset:2048 sc1
    buffer_load_dwordx4 v[100:103], v109, s[36:39], 0 offen offset:3072 sc1
    s_waitcnt vmcnt(0) lgkmcnt(0)
    v_sub_u32 v89, v89, v47
    v_sub_u32 v91, v91, v47
    v_sub_u32 v93, v93, v47
    v_sub_u32 v95, v95, v47
    v_sub_u32 v97, v97, v47
    v_sub_u32 v99, v99, v47
    v_sub_u32 v101, v101, v47
    v_sub_u32 v103, v103, v47
    v_max3_u32 v123, v89, v91, v93
    v_max3_u32 v123, v95, v97, v123
    v_max3_u32 v123, v99, v101, v123
    v_max_u32 v123, v103, v123
    v_cmp_lt_u32 vcc, 15, v123
    s_cbranch_vccnz L_hq_again
L_hq_ok:
    v_cmp_ne_u32 vcc, s85, v89
    v_cmp_ne_u32 s[94:95], s85, v97
    v_lshlrev_b32 v104, 16, v88
    v_and_b32 v105, 0xffff0000, v88
    v_lshlrev_b32 v106, 16, v96
    v_and_b32 v107, 0xffff0000, v96
    v_pk_add_f32 v[104:105], v[104:105], v[106:107]
    v_cvt_pk_bf16_f32 v64, v104, v105
    v_lshlrev_b32 v108, 16, v90
    v_and_b32 v109, 0xffff0000, v90
    v_lshlrev_b32 v110, 16, v98
    v_and_b32 v111, 0xffff0000, v98
    v_pk_add_f32 v[108:109], v[108:109], v[110:111]
    v_cvt_pk_bf16_f32 v65, v108, v109
    v_lshlrev_b32 v104, 16, v92
    v_and_b32 v105, 0xffff0000, v92
    v_lshlrev_b32 v106, 16, v100
    v_and_b32 v107, 0xffff0000, v100
    v_pk_add_f32 v[104:105], v[104:105], v[106:107]
    v_cvt_pk_bf16_f32 v66, v104, v105
    v_lshlrev_b32 v108, 16, v94
    v_and_b32 v109, 0xffff0000, v94
    v_lshlrev_b32 v110, 16, v102
    v_and_b32 v111, 0xffff0000, v102
    v_pk_add_f32 v[108:109], v[108:109], v[110:111]
    v_cvt_pk_bf16_f32 v67, v108, v109
    v_cmp_ne_u32 s[8:9], s85, v93
    s_or_b64 s[94:95], s[94:95], vcc
    v_cmp_ne_u32 vcc, s85, v101
    v_bfe_u32 v109, v0, 1, 2
    v_lshlrev_b32 v109, 8, v109
    v_bfe_u32 v108, v0, 3, 2
    v_lshl_add_u32 v109, v108, 6, v109
    v_lshrrev_b32 v108, 5, v0
    v_lshl_add_u32 v109, v108, 4, v109
    v_and_b32 v108, 1, v0
    v_lshl_add_u32 v109, v108, 3, v109
    v_add_u32 v109, 109568, v109
    s_or_b64 s[94:95], s[94:95], s[8:9]
    s_or_b64 vcc, vcc, s[94:95]
    s_cselect_b32 s75, 1, 3
    v_mov_b32 v92, s75
    ds_write_b64 v109, v[64:65]
    ds_write_b64 v109, v[66:67] offset:32
    v_mov_b32 v109, 110592
    ds_write_b32 v109, v92
    s_cmp_eq_u32 s65, 0
    s_cbranch_scc0 L_nolead
    s_lshl_b32 s75, s64, 7
    s_add_u32 s75, s75, 32768
    v_mov_b32 v88, v47
    v_mov_b32 v89, v47
    v_mov_b32 v90, v47
    v_mov_b32 v91, v47
    v_lshlrev_b32 v109, 4, v0
    s_mov_b64 exec, 0xff
    buffer_store_dwordx4 v[88:91], v109, s[36:39], s75 offen sc1
    s_mov_b64 exec, -1
L_nolead:
L_h2:
    s_cmp_lt_u32 s3, 4
    s_cbranch_scc0 L_h3
    s_add_u32 s75, s78, 2048
    v_xor_b32 v88, v2, v1
    v_lshlrev_b32 v92, 4, v88
    v_lshl_add_u32 v88, v1, 8, v92
    v_lshl_add_u32 v92, v2, 8, v92
    v_add_u32 v88, s75, v88
    v_add_u32 v92, s75, v92
    v_xor_b32 v89, 64, v88
    v_xor_b32 v93, 64, v92
    v_xor_b32 v90, 128, v88
    v_xor_b32 v94, 128, v92
    v_xor_b32 v91, 192, v88
    v_xor_b32 v95, 192, v92
    ds_write_b128 v88, v[124:127] offset:0
    ds_write_b128 v89, v[128:131] offset:1024
    ds_write_b128 v90, v[132:135] offset:2048
    ds_write_b128 v91, v[136:139] offset:3072
    ds_read_b128 v[124:127], v92 offset:0
    ds_read_b128 v[128:131], v93 offset:0
    ds_read_b128 v[132:135], v94 offset:0
    ds_read_b128 v[136:139], v95 offset:0
    s_waitcnt lgkmcnt(6)
    ds_write_b128 v88, v[140:143] offset:4096
    ds_write_b128 v89, v[144:147] offset:5120
    ds_write_b128 v90, v[148:151] offset:6144
    ds_write_b128 v91, v[152:155] offset:7168
    ds_read_b128 v[140:143], v92 offset:4096
    ds_read_b128 v[144:147], v93 offset:4096
    ds_read_b128 v[148:151], v94 offset:4096
    ds_read_b128 v[152:155], v95 offset:4096
    s_waitcnt lgkmcnt(6)
    ds_write_b128 v88, v[156:159] offset:0
    ds_write_b128 v89, v[160:163] offset:1024
    ds_write_b128 v90, v[164:167] offset:2048
    ds_write_b128 v91, v[168:171] offset:3072
    ds_read_b128 v[156:159], v92 offset:0
    ds_read_b128 v[160:163], v93 offset:0
    ds_read_b128 v[164:167], v94 offset:0
    ds_read_b128 v[168:171], v95 offset:0
    s_waitcnt lgkmcnt(6)
    ds_write_b128 v88, v[172:175] offset:4096
    ds_write_b128 v89, v[176:179] offset:5120
    ds_write_b128 v90, v[180:183] offset:6144
    ds_write_b128 v91, v[184:187] offset:7168
    ds_read_b128 v[172:175], v92 offset:4096
    ds_read_b128 v[176:179], v93 offset:4096
    ds_read_b128 v[180:183], v94 offset:4096
    ds_read_b128 v[184:187], v95 offset:4096
    s_waitcnt vmcnt(0)
L_h3:
    v_lshlrev_b32 v104, 4, v0
    v_add_u32 v104, 109568, v104
    v_mov_b32 v106, 110592
    s_cmp_lt_u32 s3, 4
    s_cbranch_scc1 L_qf
    s_cmp_eq_u32 s3, 7
    s_cbranch_scc1 L_q1wt
L_q1wt9:
    s_barrier

    s_cmp_eq_u32 s70, 1
    s_cbranch_scc1 L_pv1b
L_qf:
    ds_read_b32 v105, v106
    s_waitcnt lgkmcnt(0)
    v_cmp_eq_u32 vcc, 0, v105
    s_cbranch_vccnz L_qf_again
L_qf_ok:
    ds_read_b128 v[64:67], v104
    v_readfirstlane_b32 s69, v105
    s_nop 0
    s_lshr_b32 s69, s69, 1
    s_waitcnt lgkmcnt(0)
    s_branch L_attn
L_q:
    v_xor_b32 v46, 32, v6
    ds_read_b64_tr_b16 v[48:49], v6 offset:0
    ds_read_b64_tr_b16 v[50:51], v6 offset:1024
    ds_read_b64_tr_b16 v[52:53], v46 offset:0
    ds_read_b64_tr_b16 v[54:55], v46 offset:1024
    ds_read_b64_tr_b16 v[56:57], v6 offset:11264
    ds_read_b64_tr_b16 v[58:59], v6 offset:12288
    ds_read_b64_tr_b16 v[60:61], v46 offset:11264
    ds_read_b64_tr_b16 v[62:63], v46 offset:12288
    s_lshl_b32 s75, s101, 10
    v_add_u32 v120, s75, v7
    v_add_u32 v121, s75, v12
    v_bfe_u32 v119, v0, 2, 1
    v_lshlrev_b32 v119, 10, v119
    v_bfe_u32 v104, v0, 3, 2
    v_lshl_add_u32 v119, v104, 5, v119
    v_and_b32 v104, 3, v0
    v_lshl_add_u32 v119, v104, 3, v119
    v_lshrrev_b32 v104, 5, v0
    v_lshl_add_u32 v119, v104, 2, v119
    s_lshl_b32 s76, s3, 7
    s_add_u32 s76, s76, 106496
    v_add_u32 v119, s76, v119
    s_lshr_b32 s75, s3, 2
    s_mov_b32 s72, 32768
    s_mov_b32 s73, 327680
    s_waitcnt vmcnt(0)
    s_barrier
L_pd:
    buffer_load_dwordx4 v[72:75], v28, s[36:39], 0 offen offset:0 sc1
    buffer_load_dwordx4 v[76:79], v28, s[36:39], 0 offen offset:128 sc1
    buffer_load_dwordx4 v[80:83], v28, s[36:39], 0 offen offset:256 sc1
    buffer_load_dwordx4 v[84:87], v28, s[36:39], 0 offen offset:384 sc1
    s_waitcnt vmcnt(3)
    v_max3_u32 v123, v72, v73, v74
    s_waitcnt vmcnt(2)
    v_max3_u32 v123, v75, v76, v123
    v_max3_u32 v123, v77, v78, v123
    v_max_u32 v123, v79, v123
    v_pk_add_f32 v[72:73], v[72:73], v[76:77]
    v_pk_add_f32 v[74:75], v[74:75], v[78:79]
    s_waitcnt vmcnt(1)
    v_max3_u32 v123, v80, v81, v123
    v_max3_u32 v123, v82, v83, v123
    s_waitcnt vmcnt(0)
    v_max3_u32 v123, v84, v85, v123
    v_max3_u32 v123, v86, v87, v123
    v_cmp_eq_u32 vcc, -1, v123
    s_cbranch_vccnz L_pd_again
L_pd_ok:
    v_pk_add_f32 v[80:81], v[80:81], v[84:85]
    v_pk_add_f32 v[82:83], v[82:83], v[86:87]
    v_pk_add_f32 v[72:73], v[72:73], v[80:81]
    v_pk_add_f32 v[74:75], v[74:75], v[82:83]
    s_nop 1
    v_permlane32_swap_b32 v72, v74
    v_permlane32_swap_b32 v73, v75
    v_pk_add_f32 v[72:73], v[72:73], v[74:75]
    v_cvt_pk_bf16_f32 v72, v72, v73
    ds_write_b32 v119, v72
    ds_read_b128 v[64:67], v20
    ds_read_b128 v[68:71], v20 offset:64
    s_waitcnt lgkmcnt(1)
    v_mfma_f32_16x16x32_bf16 v[88:91], v[48:51], v[64:67], 0
    v_mfma_f32_16x16x32_bf16 v[92:95], v[52:55], v[64:67], 0
    v_mfma_f32_16x16x32_bf16 v[96:99], v[64:67], v[64:67], 0
    s_waitcnt lgkmcnt(0)
    v_mfma_f32_16x16x32_bf16 v[88:91], v[56:59], v[68:71], v[88:91]
    v_mfma_f32_16x16x32_bf16 v[92:95], v[60:63], v[68:71], v[92:95]
    v_mfma_f32_16x16x32_bf16 v[96:99], v[68:71], v[68:71], v[96:99]
    s_nop 5
    ds_write_b128 v10, v[88:91] offset:0
    ds_write_b128 v10, v[92:95] offset:128
L_qs:
    ds_write_b128 v8, v[96:99] offset:2240
    s_waitcnt lgkmcnt(0)
    s_barrier
    s_cmp_eq_u32 s3, 0
    s_cbranch_scc0 L_q2
    ds_read_b32 v112, v13 offset:0
    ds_read2st64_b32 v[104:105], v120 offset0:0 offset1:1
    ds_read2st64_b32 v[106:107], v120 offset0:2 offset1:3
    ds_read2st64_b32 v[64:65], v121 offset0:0 offset1:1
    ds_read2st64_b32 v[66:67], v121 offset0:2 offset1:3
    s_waitcnt lgkmcnt(4)
    v_add_f32_dpp v112, v112, v112 quad_perm:[1,0,3,2] row_mask:0xf bank_mask:0xf
    s_waitcnt lgkmcnt(2)
    v_pk_add_f32 v[104:105], v[104:105], v[106:107]
    v_add_f32_dpp v112, v112, v112 quad_perm:[2,3,0,1] row_mask:0xf bank_mask:0xf
    s_waitcnt lgkmcnt(0)
    v_pk_add_f32 v[64:65], v[64:65], v[66:67]
    v_add_f32_dpp v112, v112, v112 row_half_mirror row_mask:0xf bank_mask:0xf
    v_add_f32 v92, v104, v105
    v_add_f32 v93, v64, v65
    v_mul_f32_dpp v90, v112, v42 row_newbcast:8 row_mask:0xf bank_mask:0xf
    v_mul_f32_dpp v88, v112, v42 row_newbcast:0 row_mask:0xf bank_mask:0xf
    v_fma_f32 v88, -v90, v90, v88
    v_max_f32 v88, 0, v88
    v_add_f32 v88, 0x3727c5ac, v88
    v_rsq_f32 v91, v88
    v_fma_f32 v92, -v90, v93, v92
    v_mul_f32 v92, v92, v91
    s_nop 1
    v_mov_b32_dpp v94, v92 quad_perm:[1,1,3,3] row_mask:0xf bank_mask:0xf
    v_cvt_pk_bf16_f32 v96, v92, v94
    s_nop 1
    v_mov_b32_dpp v97, v96 row_shl:2 row_mask:0xf bank_mask:0xf
    v_mov_b32_dpp v98, v96 row_shl:4 row_mask:0xf bank_mask:0xf
    v_mov_b32_dpp v99, v96 row_shl:6 row_mask:0xf bank_mask:0xf
    s_mov_b64 exec, s[88:89]
    s_cmp_eq_u32 s69, 0
    s_cbranch_scc1 L_sq_wt
    buffer_store_dwordx4 v[96:99], v37, s[36:39], 0 offen
L_sq_e:
    s_mov_b64 exec, -1
    s_cmp_eq_u32 s64, 0
    s_cbranch_scc1 L_res2
L_q2:
    s_barrier
L_pq:
    buffer_load_dwordx4 v[88:91], v23, s[36:39], 0 offen offset:0 sc1
    buffer_load_dwordx4 v[92:95], v23, s[36:39], 0 offen offset:1024 sc1
    s_waitcnt vmcnt(1)
    v_max3_u32 v123, v88, v89, v90
    v_max_u32 v123, v91, v123
    v_lshlrev_b32 v104, 16, v88
    v_and_b32 v105, 0xffff0000, v88
    v_lshlrev_b32 v106, 16, v89
    v_and_b32 v107, 0xffff0000, v89
    v_lshlrev_b32 v108, 16, v90
    v_and_b32 v109, 0xffff0000, v90
    v_lshlrev_b32 v110, 16, v91
    v_and_b32 v111, 0xffff0000, v91
    s_waitcnt vmcnt(0)
    v_max3_u32 v123, v92, v93, v123
    v_max3_u32 v123, v94, v95, v123
    v_cmp_eq_u32 vcc, -1, v123
    s_cbranch_vccnz L_pq_again
L_pq_ok:
    v_lshlrev_b32 v96, 16, v92
    v_and_b32 v97, 0xffff0000, v92
    v_pk_add_f32 v[96:97], v[96:97], v[104:105]
    v_cvt_pk_bf16_f32 v64, v96, v97
    v_lshlrev_b32 v98, 16, v93
    v_and_b32 v99, 0xffff0000, v93
    v_pk_add_f32 v[98:99], v[98:99], v[106:107]
    v_cvt_pk_bf16_f32 v65, v98, v99
    v_lshlrev_b32 v96, 16, v94
    v_and_b32 v97, 0xffff0000, v94
    v_pk_add_f32 v[96:97], v[96:97], v[108:109]
    v_cvt_pk_bf16_f32 v66, v96, v97
    v_lshlrev_b32 v98, 16, v95
    v_and_b32 v99, 0xffff0000, v95
    v_pk_add_f32 v[98:99], v[98:99], v[110:111]
    v_cvt_pk_bf16_f32 v67, v98, v99
L_attn:
    s_nop 1
    v_mfma_f32_16x16x32_bf16 v[92:95], v[144:147], v[64:67], 0
    v_mov_b32_dpp v68, v64 row_ror:12 row_mask:0xf bank_mask:0xf
    v_mov_b32_dpp v69, v65 row_ror:12 row_mask:0xf bank_mask:0xf
    v_mov_b32_dpp v70, v66 row_ror:12 row_mask:0xf bank_mask:0xf
    v_mov_b32_dpp v71, v67 row_ror:12 row_mask:0xf bank_mask:0xf
    v_mfma_f32_16x16x32_bf16 v[96:99], v[164:167], v[64:67], 0
    v_mov_b32_dpp v72, v64 row_ror:8 row_mask:0xf bank_mask:0xf
    v_mov_b32_dpp v73, v65 row_ror:8 row_mask:0xf bank_mask:0xf
    v_mov_b32_dpp v74, v66 row_ror:8 row_mask:0xf bank_mask:0xf
    v_mov_b32_dpp v75, v67 row_ror:8 row_mask:0xf bank_mask:0xf
    v_mfma_f32_16x16x32_bf16 v[100:103], v[184:187], v[64:67], 0
    v_mov_b32_dpp v76, v64 row_ror:4 row_mask:0xf bank_mask:0xf
    v_mov_b32_dpp v77, v65 row_ror:4 row_mask:0xf bank_mask:0xf
    v_mov_b32_dpp v78, v66 row_ror:4 row_mask:0xf bank_mask:0xf
    v_mov_b32_dpp v79, v67 row_ror:4 row_mask:0xf bank_mask:0xf
    v_mfma_f32_16x16x32_bf16 v[92:95], v[148:151], v[68:71], v[92:95]
    v_mfma_f32_16x16x32_bf16 v[92:95], v[152:155], v[72:75], v[92:95]
    v_mfma_f32_16x16x32_bf16 v[92:95], v[140:143], v[76:79], v[92:95]
    v_mfma_f32_16x16x32_bf16 v[96:99], v[168:171], v[68:71], v[96:99]
    v_mfma_f32_16x16x32_bf16 v[96:99], v[156:159], v[72:75], v[96:99]
    v_mfma_f32_16x16x32_bf16 v[96:99], v[160:163], v[76:79], v[96:99]
    v_mfma_f32_16x16x32_bf16 v[100:103], v[172:175], v[68:71], v[100:103]
    v_mfma_f32_16x16x32_bf16 v[100:103], v[176:179], v[72:75], v[100:103]
    v_mfma_f32_16x16x32_bf16 v[100:103], v[180:183], v[76:79], v[100:103]
    v_mfma_f32_16x16x32_bf16 v[88:91], v[124:127], v[64:67], 0
    v_mfma_f32_16x16x32_bf16 v[88:91], v[128:131], v[68:71], v[88:91]
    v_mov_b32_dpp v104, v92 quad_perm:[0,1,2,3] row_mask:0xf bank_mask:2
    v_mov_b32_dpp v105, v93 quad_perm:[0,1,2,3] row_mask:0xf bank_mask:2
    v_mov_b32_dpp v106, v94 quad_perm:[0,1,2,3] row_mask:0xf bank_mask:2
    v_mov_b32_dpp v107, v95 quad_perm:[0,1,2,3] row_mask:0xf bank_mask:2
    v_mfma_f32_16x16x32_bf16 v[88:91], v[132:135], v[72:75], v[88:91]
    v_mov_b32_dpp v104, v96 quad_perm:[0,1,2,3] row_mask:0xf bank_mask:4
    v_mov_b32_dpp v105, v97 quad_perm:[0,1,2,3] row_mask:0xf bank_mask:4
    v_mov_b32_dpp v106, v98 quad_perm:[0,1,2,3] row_mask:0xf bank_mask:4
    v_mov_b32_dpp v107, v99 quad_perm:[0,1,2,3] row_mask:0xf bank_mask:4
    v_mfma_f32_16x16x32_bf16 v[88:91], v[136:139], v[76:79], v[88:91]
    v_mov_b32_dpp v104, v100 quad_perm:[0,1,2,3] row_mask:0xf bank_mask:8
    v_mov_b32_dpp v105, v101 quad_perm:[0,1,2,3] row_mask:0xf bank_mask:8
    v_mov_b32_dpp v106, v102 quad_perm:[0,1,2,3] row_mask:0xf bank_mask:8
    v_mov_b32_dpp v107, v103 quad_perm:[0,1,2,3] row_mask:0xf bank_mask:8
    s_nop 3
    v_mov_b32_dpp v104, v88 quad_perm:[0,1,2,3] row_mask:0xf bank_mask:1
    v_mov_b32_dpp v105, v89 quad_perm:[0,1,2,3] row_mask:0xf bank_mask:1
    v_mov_b32_dpp v106, v90 quad_perm:[0,1,2,3] row_mask:0xf bank_mask:1
    v_mov_b32_dpp v107, v91 quad_perm:[0,1,2,3] row_mask:0xf bank_mask:1
    v_max3_f32 v108, v104, v105, v106
    v_max_f32 v108, v108, v107
    s_nop 1
    v_max_f32_dpp v108, v108, v108 row_ror:4 row_mask:0xf bank_mask:0xf
    s_nop 1
    v_max_f32_dpp v108, v108, v108 row_ror:8 row_mask:0xf bank_mask:0xf
    v_mov_b32 v110, v108
    s_nop 1
    v_permlane16_swap_b32 v108, v110
    v_max_f32 v108, v108, v110
    v_mov_b32 v110, v108
    s_nop 1
    v_permlane32_swap_b32 v108, v110
    v_max_f32 v108, v108, v110
    v_mul_f32 v108, v108, v41
    v_fma_f32 v104, v104, v41, -v108
    v_fma_f32 v105, v105, v41, -v108
    v_fma_f32 v106, v106, v41, -v108
    v_fma_f32 v107, v107, v41, -v108
    v_exp_f32 v104, v104
    v_exp_f32 v105, v105
    v_exp_f32 v106, v106
    v_exp_f32 v107, v107
    s_cmp_eq_u32 s72, 0
    v_cvt_pk_bf16_f32 v112, v104, v105
    v_cvt_pk_bf16_f32 v113, v106, v107
    s_cbranch_scc1 L_pv1
    s_nop 0
    v_mfma_f32_4x4x4_16b_bf16 v[88:91], v[112:113], v[188:189], 0 cbsz:4 abid:0
    v_mfma_f32_4x4x4_16b_bf16 v[92:95], v[112:113], v[190:191], 0 cbsz:4 abid:0
    v_pk_add_f32 v[104:105], v[104:105], v[106:107]
    v_mfma_f32_4x4x4_16b_bf16 v[88:91], v[112:113], v[192:193], v[88:91] cbsz:4 abid:1
    v_mfma_f32_4x4x4_16b_bf16 v[92:95], v[112:113], v[194:195], v[92:95] cbsz:4 abid:1
    v_add_f32 v109, v104, v105
    v_mfma_f32_4x4x4_16b_bf16 v[88:91], v[112:113], v[196:197], v[88:91] cbsz:4 abid:2
    v_mfma_f32_4x4x4_16b_bf16 v[92:95], v[112:113], v[198:199], v[92:95] cbsz:4 abid:2
    v_add_f32_dpp v109, v109, v109 row_ror:4 row_mask:0xf bank_mask:0xf
    v_mfma_f32_4x4x4_16b_bf16 v[88:91], v[112:113], v[200:201], v[88:91] cbsz:4 abid:3
    v_mfma_f32_4x4x4_16b_bf16 v[92:95], v[112:113], v[202:203], v[92:95] cbsz:4 abid:3
    v_add_f32_dpp v109, v109, v109 row_ror:8 row_mask:0xf bank_mask:0xf
    v_mfma_f32_4x4x4_16b_bf16 v[88:91], v[112:113], v[204:205], v[88:91] cbsz:4 abid:4
    v_mfma_f32_4x4x4_16b_bf16 v[92:95], v[112:113], v[206:207], v[92:95] cbsz:4 abid:4
    v_mov_b32 v110, v109
    v_mfma_f32_4x4x4_16b_bf16 v[88:91], v[112:113], v[208:209], v[88:91] cbsz:4 abid:5
    v_mfma_f32_4x4x4_16b_bf16 v[92:95], v[112:113], v[210:211], v[92:95] cbsz:4 abid:5
    v_permlane16_swap_b32 v109, v110
    v_mfma_f32_4x4x4_16b_bf16 v[88:91], v[112:113], v[212:213], v[88:91] cbsz:4 abid:6
    v_mfma_f32_4x4x4_16b_bf16 v[92:95], v[112:113], v[214:215], v[92:95] cbsz:4 abid:6
    v_add_f32 v109, v109, v110
    v_mfma_f32_4x4x4_16b_bf16 v[88:91], v[112:113], v[216:217], v[88:91] cbsz:4 abid:7
    v_mfma_f32_4x4x4_16b_bf16 v[92:95], v[112:113], v[218:219], v[92:95] cbsz:4 abid:7
    v_mov_b32 v110, v109
    v_mfma_f32_4x4x4_16b_bf16 v[88:91], v[112:113], v[220:221], v[88:91] cbsz:4 abid:8
    v_mfma_f32_4x4x4_16b_bf16 v[92:95], v[112:113], v[222:223], v[92:95] cbsz:4 abid:8
    v_permlane32_swap_b32 v109, v110
    v_mfma_f32_4x4x4_16b_bf16 v[88:91], v[112:113], v[224:225], v[88:91] cbsz:4 abid:9
    v_mfma_f32_4x4x4_16b_bf16 v[92:95], v[112:113], v[226:227], v[92:95] cbsz:4 abid:9
    v_add_f32 v109, v109, v110
    v_mfma_f32_4x4x4_16b_bf16 v[88:91], v[112:113], v[228:229], v[88:91] cbsz:4 abid:10
    v_mfma_f32_4x4x4_16b_bf16 v[92:95], v[112:113], v[230:231], v[92:95] cbsz:4 abid:10
    ds_write_b64 v17, v[108:109]
    v_mfma_f32_4x4x4_16b_bf16 v[88:91], v[112:113], v[232:233], v[88:91] cbsz:4 abid:11
    v_mfma_f32_4x4x4_16b_bf16 v[92:95], v[112:113], v[234:235], v[92:95] cbsz:4 abid:11
    s_nop 0
    v_mfma_f32_4x4x4_16b_bf16 v[88:91], v[112:113], v[236:237], v[88:91] cbsz:4 abid:12
    v_mfma_f32_4x4x4_16b_bf16 v[92:95], v[112:113], v[238:239], v[92:95] cbsz:4 abid:12
    s_nop 0
    v_mfma_f32_4x4x4_16b_bf16 v[88:91], v[112:113], v[240:241], v[88:91] cbsz:4 abid:13
    v_mfma_f32_4x4x4_16b_bf16 v[92:95], v[112:113], v[242:243], v[92:95] cbsz:4 abid:13
    s_nop 0
    v_mfma_f32_4x4x4_16b_bf16 v[88:91], v[112:113], v[244:245], v[88:91] cbsz:4 abid:14
    v_mfma_f32_4x4x4_16b_bf16 v[92:95], v[112:113], v[246:247], v[92:95] cbsz:4 abid:14
    s_nop 0
    v_mfma_f32_4x4x4_16b_bf16 v[88:91], v[112:113], v[248:249], v[88:91] cbsz:4 abid:15
    v_mfma_f32_4x4x4_16b_bf16 v[92:95], v[112:113], v[250:251], v[92:95] cbsz:4 abid:15
    s_nop 2
L_pv3:
    s_or_b32 s75, s72, s3
    s_cmp_lt_u32 s75, 4
    ds_write2_b32 v14, v88, v92 offset0:0 offset1:1
    ds_write2_b32 v14, v89, v93 offset0:128 offset1:129
    ds_write2_b32 v15, v90, v94 offset0:0 offset1:1
    ds_write2_b32 v15, v91, v95 offset0:128 offset1:129
    s_cbranch_scc1 L_late
L_nolate:
    s_cmp_lt_u32 s3, 4
    s_waitcnt lgkmcnt(0)
    s_barrier
    s_cbranch_scc0 L_yw
    ds_read_b64 v[104:105], v18
    ds_read_b64 v[64:65], v16 offset:0
    ds_read_b64 v[66:67], v16 offset:2048
    ds_read_b64 v[68:69], v16 offset:4096
    ds_read_b64 v[70:71], v16 offset:6144
    ds_read_b64 v[72:73], v16 offset:8192
    ds_read_b64 v[74:75], v16 offset:10240
    ds_read_b64 v[76:77], v16 offset:12288
    ds_read_b64 v[78:79], v16 offset:14336
    s_waitcnt lgkmcnt(8)
    v_max_f32_dpp v106, v104, v104 row_ror:4 row_mask:0xf bank_mask:0xf
    s_nop 1
    v_max_f32_dpp v106, v106, v106 row_ror:2 row_mask:0xf bank_mask:0xf
    s_nop 1
    v_max_f32_dpp v106, v106, v106 row_ror:1 row_mask:0xf bank_mask:0xf
    v_sub_f32 v108, v104, v106
    v_exp_f32 v108, v108
    s_nop 0
    v_mul_f32 v107, v108, v105
    s_waitcnt lgkmcnt(4)
    v_mul_f32_dpp v109, v108, v64 row_newbcast:0 row_mask:0xf bank_mask:0xf
    v_mul_f32_dpp v110, v108, v65 row_newbcast:0 row_mask:0xf bank_mask:0xf
    v_add_f32_dpp v107, v107, v107 row_ror:4 row_mask:0xf bank_mask:0xf
    v_fmac_f32_dpp v109, v108, v66 row_newbcast:1 row_mask:0xf bank_mask:0xf
    v_fmac_f32_dpp v110, v108, v67 row_newbcast:1 row_mask:0xf bank_mask:0xf
    v_add_f32_dpp v107, v107, v107 row_ror:2 row_mask:0xf bank_mask:0xf
    v_fmac_f32_dpp v109, v108, v68 row_newbcast:2 row_mask:0xf bank_mask:0xf
    v_fmac_f32_dpp v110, v108, v69 row_newbcast:2 row_mask:0xf bank_mask:0xf
    v_add_f32_dpp v107, v107, v107 row_ror:1 row_mask:0xf bank_mask:0xf
    v_fmac_f32_dpp v109, v108, v70 row_newbcast:3 row_mask:0xf bank_mask:0xf
    v_fmac_f32_dpp v110, v108, v71 row_newbcast:3 row_mask:0xf bank_mask:0xf
    s_waitcnt lgkmcnt(0)
    v_fmac_f32_dpp v109, v108, v72 row_newbcast:4 row_mask:0xf bank_mask:0xf
    v_fmac_f32_dpp v110, v108, v73 row_newbcast:4 row_mask:0xf bank_mask:0xf
    v_fmac_f32_dpp v109, v108, v74 row_newbcast:5 row_mask:0xf bank_mask:0xf
    v_fmac_f32_dpp v110, v108, v75 row_newbcast:5 row_mask:0xf bank_mask:0xf
    v_fmac_f32_dpp v109, v108, v76 row_newbcast:6 row_mask:0xf bank_mask:0xf
    v_fmac_f32_dpp v110, v108, v77 row_newbcast:6 row_mask:0xf bank_mask:0xf
    v_fmac_f32_dpp v109, v108, v78 row_newbcast:7 row_mask:0xf bank_mask:0xf
    v_fmac_f32_dpp v110, v108, v79 row_newbcast:7 row_mask:0xf bank_mask:0xf
    v_cvt_pk_bf16_f32 v109, v109, v110
    s_cmp_eq_u32 s69, 0
    s_cbranch_scc1 L_so_wt
    buffer_store_dword v109, v32, s[36:39], s73 offen
    s_mov_b64 exec, 1
    buffer_store_dwordx2 v[106:107], v33, s[36:39], s72 offen
L_so_e:
    s_mov_b64 exec, -1
L_wo:
    s_barrier
L_pa:
    buffer_load_dwordx2 v[104:105], v25, s[36:39], s72 offen sc1
    buffer_load_dwordx4 v[64:67], v24, s[36:39], s73 offen sc1
    buffer_load_dwordx4 v[68:71], v24, s[36:39], s73 offen offset:1024 sc1
    ds_read_b64_tr_b16 v[48:49], v4 offset:2048
    ds_read_b64_tr_b16 v[50:51], v4 offset:3072
    ds_read_b64_tr_b16 v[52:53], v5 offset:2048
    ds_read_b64_tr_b16 v[54:55], v5 offset:3072
    ds_read_b64_tr_b16 v[56:57], v4 offset:4096
    ds_read_b64_tr_b16 v[58:59], v4 offset:5120
    ds_read_b64_tr_b16 v[60:61], v5 offset:4096
    ds_read_b64_tr_b16 v[62:63], v5 offset:5120
    s_waitcnt vmcnt(2)
    v_max_u32 v123, v104, v105
    v_max_f32_dpp v106, v104, v104 row_ror:8 row_mask:0xf bank_mask:0xf
    s_nop 1
    v_max_f32_dpp v106, v106, v106 row_ror:4 row_mask:0xf bank_mask:0xf
    s_nop 1
    v_max_f32_dpp v106, v106, v106 row_ror:2 row_mask:0xf bank_mask:0xf
    s_nop 1
    v_max_f32_dpp v106, v106, v106 row_ror:1 row_mask:0xf bank_mask:0xf
    v_sub_f32 v107, v104, v106
    v_exp_f32 v107, v107
    s_nop 0
    v_mul_f32 v108, v107, v105
    s_waitcnt vmcnt(1)
    v_max3_u32 v123, v64, v65, v123
    v_max3_u32 v123, v66, v67, v123
    s_waitcnt vmcnt(0)
    v_max3_u32 v123, v68, v69, v123
    v_max3_u32 v123, v70, v71, v123
    v_cmp_eq_u32 vcc, -1, v123
    s_cbranch_vccnz L_pa_again
L_pa_ok:
    s_cmp_eq_u32 s72, 0
    s_cbranch_scc0 L_pa2

    ds_read_b64_tr_b16 v[48:49], v4 offset:2048
    ds_read_b64_tr_b16 v[50:51], v4 offset:3072
    ds_read_b64_tr_b16 v[52:53], v5 offset:2048
    ds_read_b64_tr_b16 v[54:55], v5 offset:3072
    ds_read_b64_tr_b16 v[56:57], v4 offset:4096
    ds_read_b64_tr_b16 v[58:59], v4 offset:5120
    ds_read_b64_tr_b16 v[60:61], v5 offset:4096
    ds_read_b64_tr_b16 v[62:63], v5 offset:5120
    s_cmp_eq_u32 s3, 7
    s_cbranch_scc1 L_gf0
L_gf_ok:
    s_cmp_lt_u32 s65, 14
    s_cbranch_scc0 L_pa2
    v_mul_u32_u24 v46, 3584, v39
    v_add_u32 v46, v46, v40
    s_mov_b32 s75, 114688
    s_add_u32 m0, s78, 6144
    s_nop 0
    buffer_load_dwordx4 v46, s[52:55], 0 offen  lds
    s_add_u32 m0, s78, 7168
    s_nop 0
    buffer_load_dwordx4 v46, s[52:55], s75 offen  lds
L_pa2:
    s_waitcnt lgkmcnt(0)
    v_mfma_f32_16x16x32_bf16 v[88:91], v[64:67], v[48:51], 0
    v_add_f32_dpp v108, v108, v108 row_ror:8 row_mask:0xf bank_mask:0xf
    v_mfma_f32_16x16x32_bf16 v[88:91], v[68:71], v[56:59], v[88:91]
    v_mfma_f32_16x16x32_bf16 v[92:95], v[64:67], v[52:55], 0
    v_add_f32_dpp v108, v108, v108 row_ror:4 row_mask:0xf bank_mask:0xf
    v_mfma_f32_16x16x32_bf16 v[92:95], v[68:71], v[60:63], v[92:95]
    s_cmp_eq_u32 s3, 0
    v_add_f32_dpp v108, v108, v108 row_ror:2 row_mask:0xf bank_mask:0xf
    s_nop 1
    v_add_f32_dpp v108, v108, v108 row_ror:1 row_mask:0xf bank_mask:0xf
    v_rcp_f32 v108, v108
    v_mul_f32_dpp v109, v107, v88 row_newbcast:0 row_mask:0xf bank_mask:0xf
    v_fmac_f32_dpp v109, v107, v89 row_newbcast:1 row_mask:0xf bank_mask:0xf
    v_fmac_f32_dpp v109, v107, v90 row_newbcast:2 row_mask:0xf bank_mask:0xf
    v_fmac_f32_dpp v109, v107, v91 row_newbcast:3 row_mask:0xf bank_mask:0xf
    v_mul_f32_dpp v110, v107, v92 row_newbcast:0 row_mask:0xf bank_mask:0xf
    v_fmac_f32_dpp v110, v107, v93 row_newbcast:1 row_mask:0xf bank_mask:0xf
    v_fmac_f32_dpp v110, v107, v94 row_newbcast:2 row_mask:0xf bank_mask:0xf
    v_fmac_f32_dpp v110, v107, v95 row_newbcast:3 row_mask:0xf bank_mask:0xf
    s_nop 1
    v_permlane32_swap_b32 v109, v110
    v_add_f32 v109, v109, v110
    v_mul_f32 v110, v109, v108
    v_mul_f32 v109, v109, v108
    s_nop 1
    v_permlane16_swap_b32 v109, v110
    v_add_f32 v109, v109, v110
    ds_write_b32 v9, v109 offset:4096
    s_waitcnt lgkmcnt(0)
    s_barrier
    s_cbranch_scc0 L_roles
    ds_read2st64_b32 v[104:105], v7 offset0:16 offset1:17
    ds_read2st64_b32 v[106:107], v7 offset0:18 offset1:19
    ds_read2st64_b32 v[108:109], v7 offset0:20 offset1:21
    ds_read2st64_b32 v[110:111], v7 offset0:22 offset1:23
    s_waitcnt lgkmcnt(3)
    v_add_f32 v104, v104, v105
    s_waitcnt lgkmcnt(2)
    v_add_f32 v106, v106, v107
    v_add_f32 v104, v104, v106
    v_add_f32 v104, v104, v43
    s_waitcnt lgkmcnt(1)
    v_add_f32 v108, v108, v109
    s_waitcnt lgkmcnt(0)
    v_add_f32 v110, v110, v111
    v_add_f32 v108, v108, v110
    v_add_f32 v112, v104, v108
    s_nop 1
    v_mov_b32_dpp v113, v112 quad_perm:[1,1,1,1] row_mask:0xf bank_mask:0xf
    v_mov_b32_dpp v114, v112 quad_perm:[2,2,2,2] row_mask:0xf bank_mask:0xf
    v_mov_b32_dpp v115, v112 quad_perm:[3,3,3,3] row_mask:0xf bank_mask:0xf
    s_mov_b64 exec, s[92:93]
    buffer_store_dwordx4 v[112:115], v34, s[36:39], s72 offen sc1
    s_mov_b64 exec, -1
L_roles:
    s_cmp_lt_u32 s65, 14
    s_cbranch_scc0 L_nogu
    s_cmp_eq_u32 s72, 0
    s_cbranch_scc1 L_gu0
    s_waitcnt vmcnt(0)
L_gu1:
    s_barrier
L_pb:
    buffer_load_dwordx4 v[72:75], v26, s[36:39], s72 offen offset:0 sc1
    buffer_load_dwordx4 v[76:79], v26, s[36:39], s72 offen offset:128 sc1
    buffer_load_dwordx4 v[80:83], v26, s[36:39], s72 offen offset:256 sc1
    buffer_load_dwordx4 v[84:87], v26, s[36:39], s72 offen offset:384 sc1
    s_waitcnt vmcnt(3)
    ds_read_b64_tr_b16 v[48:49], v3 offset:6144
    ds_read_b64_tr_b16 v[50:51], v3 offset:6656
    ds_read_b64_tr_b16 v[52:53], v3 offset:7168
    ds_read_b64_tr_b16 v[54:55], v3 offset:7680
    ds_read_b64_tr_b16 v[56:57], v3 offset:8192
    ds_read_b64_tr_b16 v[58:59], v3 offset:8704
    ds_read_b64_tr_b16 v[60:61], v3 offset:9216
    ds_read_b64_tr_b16 v[62:63], v3 offset:9728
    v_max3_u32 v123, v72, v73, v74
    s_waitcnt vmcnt(2)
    v_max3_u32 v123, v75, v76, v123
    v_max3_u32 v123, v77, v78, v123
    v_max_u32 v123, v79, v123
    v_pk_add_f32 v[72:73], v[72:73], v[76:77]
    v_pk_add_f32 v[74:75], v[74:75], v[78:79]
    s_waitcnt vmcnt(1)
    v_max3_u32 v123, v80, v81, v123
    v_max3_u32 v123, v82, v83, v123
    s_waitcnt vmcnt(0)
    v_max3_u32 v123, v84, v85, v123
    v_max3_u32 v123, v86, v87, v123
    v_cmp_eq_u32 vcc, -1, v123
    s_cbranch_vccnz L_pb_again
L_pb_ok:
    v_pk_add_f32 v[80:81], v[80:81], v[84:85]
    v_pk_add_f32 v[82:83], v[82:83], v[86:87]
    v_pk_add_f32 v[72:73], v[72:73], v[80:81]
    v_pk_add_f32 v[74:75], v[74:75], v[82:83]
    s_nop 1
    v_permlane32_swap_b32 v72, v74
    v_permlane32_swap_b32 v73, v75
    v_pk_add_f32 v[72:73], v[72:73], v[74:75]
    v_cvt_pk_bf16_f32 v72, v72, v73
    ds_write_b32 v19, v72
    ds_read_b128 v[64:67], v20
    ds_read_b128 v[68:71], v20 offset:64
    v_lshl_add_u32 v46, v39, 10, v40
    s_add_u32 m0, s78, 10240
    s_nop 0
    buffer_load_dwordx4 v46, s[4:7], 0 offen  lds
    s_waitcnt lgkmcnt(1)
    v_mfma_f32_16x16x32_bf16 v[88:91], v[48:51], v[64:67], 0
    v_mfma_f32_16x16x32_bf16 v[92:95], v[56:59], v[64:67], 0
    v_mfma_f32_16x16x32_bf16 v[96:99], v[64:67], v[64:67], 0
    s_waitcnt lgkmcnt(0)
    v_mfma_f32_16x16x32_bf16 v[88:91], v[52:55], v[68:71], v[88:91]
    v_mfma_f32_16x16x32_bf16 v[92:95], v[60:63], v[68:71], v[92:95]
    v_mfma_f32_16x16x32_bf16 v[96:99], v[68:71], v[68:71], v[96:99]
    s_add_u32 s75, s72, 131072
    s_cmp_eq_u32 s3, 0
    s_nop 3
    ds_write_b128 v10, v[88:91] offset:6144
    ds_write_b128 v10, v[92:95] offset:6272
    ds_write_b128 v8, v[96:99] offset:8384
    s_waitcnt lgkmcnt(0)
    s_barrier
    s_cbranch_scc0 L_dn
    ds_read_b32 v112, v13 offset:6144
    ds_read2st64_b32 v[104:105], v7 offset0:24 offset1:25
    ds_read2st64_b32 v[106:107], v7 offset0:26 offset1:27
    ds_read2st64_b32 v[108:109], v7 offset0:28 offset1:29
    ds_read2st64_b32 v[110:111], v7 offset0:30 offset1:31
    ds_read2st64_b32 v[64:65], v12 offset0:24 offset1:25
    ds_read2st64_b32 v[66:67], v12 offset0:26 offset1:27
    ds_read2st64_b32 v[68:69], v12 offset0:28 offset1:29
    ds_read2st64_b32 v[70:71], v12 offset0:30 offset1:31
    s_waitcnt lgkmcnt(8)
    v_add_f32_dpp v112, v112, v112 quad_perm:[1,0,3,2] row_mask:0xf bank_mask:0xf
    s_waitcnt lgkmcnt(6)
    v_pk_add_f32 v[104:105], v[104:105], v[106:107]
    v_add_f32_dpp v112, v112, v112 quad_perm:[2,3,0,1] row_mask:0xf bank_mask:0xf
    s_waitcnt lgkmcnt(4)
    v_pk_add_f32 v[108:109], v[108:109], v[110:111]
    v_add_f32_dpp v112, v112, v112 row_half_mirror row_mask:0xf bank_mask:0xf
    s_waitcnt lgkmcnt(2)
    v_pk_add_f32 v[64:65], v[64:65], v[66:67]
    v_mul_f32_dpp v90, v112, v42 row_newbcast:8 row_mask:0xf bank_mask:0xf
    v_mul_f32_dpp v88, v112, v42 row_newbcast:0 row_mask:0xf bank_mask:0xf
    v_pk_add_f32 v[104:105], v[104:105], v[108:109]
    s_waitcnt lgkmcnt(0)
    v_pk_add_f32 v[68:69], v[68:69], v[70:71]
    v_fma_f32 v88, -v90, v90, v88
    v_max_f32 v88, 0, v88
    v_add_f32 v88, 0x3727c5ac, v88
    v_rsq_f32 v91, v88
    v_pk_add_f32 v[64:65], v[64:65], v[68:69]
    v_add_f32 v92, v104, v105
    v_add_f32 v93, v64, v65
    v_fma_f32 v92, -v90, v93, v92
    v_mul_f32 v92, v92, v91
    v_mov_b32 v94, v92
    s_nop 1
    v_permlane32_swap_b32 v92, v94
    v_max_f32 v92, 0, v92
    v_mul_f32 v92, v92, v94
    s_nop 1
    v_mov_b32_dpp v94, v92 quad_perm:[1,1,3,3] row_mask:0xf bank_mask:0xf
    v_cvt_pk_bf16_f32 v96, v92, v94
    s_nop 1
    v_mov_b32_dpp v97, v96 row_shl:2 row_mask:0xf bank_mask:0xf
    v_mov_b32_dpp v98, v96 row_shl:4 row_mask:0xf bank_mask:0xf
    v_mov_b32_dpp v99, v96 row_shl:6 row_mask:0xf bank_mask:0xf
    s_mov_b64 exec, s[90:91]
    s_cmp_eq_u32 s69, 0
    s_cbranch_scc1 L_sh_wt
    buffer_store_dwordx4 v[96:99], v36, s[36:39], s75 offen
L_sh_e:
    s_mov_b64 exec, -1
L_dn:
    s_cmp_eq_u32 s3, 7
    s_cbranch_scc1 L_dn7
    s_or_b32 s75, s3, s64
    s_cmp_eq_u32 s75, 0
    s_cbranch_scc1 L_x1
L_dn0:
    s_waitcnt vmcnt(0)
    ds_read_b64_tr_b16 v[48:49], v3 offset:10240
    ds_read_b64_tr_b16 v[50:51], v3 offset:10752
    s_mov_b64 exec, s[86:87]
L_pc2:
    buffer_load_dwordx4 v[64:67], v27, s[36:39], s72 offen sc1
    s_waitcnt vmcnt(0)
    v_max3_u32 v123, v64, v65, v66
    v_max_u32 v123, v67, v123
    v_cmp_eq_u32 vcc, -1, v123
    s_cbranch_vccnz L_pc2_again
L_pc2_ok:
    s_mov_b64 exec, -1
    s_waitcnt lgkmcnt(0)
    v_mfma_f32_16x16x32_bf16 v[88:91], v[48:51], v[64:67], 0
    s_nop 7
    ds_write_b128 v11, v[88:91] offset:10240
    s_waitcnt lgkmcnt(0)
L_dn1:
    s_cmp_eq_u32 s3, 0
    s_barrier
    s_cbranch_scc0 L_dn2
    ds_read2st64_b32 v[104:105], v7 offset0:40 offset1:41
    ds_read2st64_b32 v[106:107], v7 offset0:42 offset1:43
    ds_read2st64_b32 v[108:109], v7 offset0:44 offset1:45
    ds_read2st64_b32 v[110:111], v7 offset0:46 offset1:47
    s_waitcnt lgkmcnt(3)
    v_add_f32 v104, v104, v105
    s_waitcnt lgkmcnt(2)
    v_add_f32 v106, v106, v107
    v_add_f32 v104, v104, v106
    v_add_f32 v104, v104, v44
    s_waitcnt lgkmcnt(1)
    v_add_f32 v108, v108, v109
    s_waitcnt lgkmcnt(0)
    v_add_f32 v110, v110, v111
    v_add_f32 v108, v108, v110
    v_add_f32 v112, v104, v108
    s_nop 1
    v_mov_b32_dpp v113, v112 quad_perm:[1,1,1,1] row_mask:0xf bank_mask:0xf
    v_mov_b32_dpp v114, v112 quad_perm:[2,2,2,2] row_mask:0xf bank_mask:0xf
    v_mov_b32_dpp v115, v112 quad_perm:[3,3,3,3] row_mask:0xf bank_mask:0xf
    s_mov_b64 exec, s[96:97]
    buffer_store_dwordx4 v[112:115], v35, s[36:39], s72 offen sc1
    s_mov_b64 exec, -1
L_dn2:
    s_cmp_eq_u32 s72, 0
    s_cbranch_scc1 L_q
    s_and_b32 s75, s65, 7
    s_xor_b32 s75, s75, s64
    s_or_b32 s75, s75, s3
    s_cbranch_scc1 L_done
    s_waitcnt vmcnt(0)
L_pf:
    buffer_load_dword v104, v30, s[36:39], s72 offen offset:0 sc1
    buffer_load_dword v105, v30, s[36:39], s72 offen offset:128 sc1
    buffer_load_dword v106, v30, s[36:39], s72 offen offset:256 sc1
    buffer_load_dword v107, v30, s[36:39], s72 offen offset:384 sc1
    s_waitcnt vmcnt(3)
    s_waitcnt vmcnt(2)
    s_waitcnt vmcnt(1)
    v_max3_u32 v123, v104, v105, v106
    s_waitcnt vmcnt(0)
    v_max_u32 v123, v107, v123
    v_cmp_eq_u32 vcc, -1, v123
    s_cbranch_vccnz L_pf_again
L_pf_ok:
    v_add_f32 v104, v104, v105
    v_add_f32 v106, v106, v107
    v_add_f32 v88, v104, v106
    v_mov_b32 v104, v88
    s_nop 1
    v_permlane32_swap_b32 v88, v104
    v_add_f32 v88, v88, v104
    s_nop 1
    v_mov_b32_dpp v89, v88 quad_perm:[1,1,3,3] row_mask:0xf bank_mask:0xf
    v_cvt_pk_bf16_f32 v92, v88, v89
    s_nop 1
    v_mov_b32_dpp v93, v92 row_shl:2 row_mask:0xf bank_mask:0xf
    v_mov_b32_dpp v94, v92 row_shl:4 row_mask:0xf bank_mask:0xf
    v_mov_b32_dpp v95, v92 row_shl:6 row_mask:0xf bank_mask:0xf
    s_mov_b64 exec, s[90:91]
    buffer_store_dwordx4 v[92:95], v38, s[60:63], 0 offen
L_done:
L_end:
    s_endpgm
L_q1wt:
    ds_read_b32 v105, v106
    s_waitcnt lgkmcnt(0)
    v_cmp_eq_u32 vcc, 3, v105
    s_cbranch_vccnz L_q1wt9
    s_mov_b64 exec, 0xffff
    buffer_store_dwordx4 v[80:83], v84, s[36:39], 0 offen sc1
    s_mov_b64 exec, -1
    s_waitcnt vmcnt(0)
    s_branch L_q1wt9
L_mid:
    s_add_u32 s75, s78, 2048
    v_xor_b32 v88, v2, v1
    v_lshlrev_b32 v92, 4, v88
    v_lshl_add_u32 v88, v1, 8, v92
    v_lshl_add_u32 v92, v2, 8, v92
    v_add_u32 v88, s75, v88
    v_add_u32 v92, s75, v92
    v_xor_b32 v89, 64, v88
    v_xor_b32 v93, 64, v92
    v_xor_b32 v90, 128, v88
    v_xor_b32 v94, 128, v92
    v_xor_b32 v91, 192, v88
    v_xor_b32 v95, 192, v92
    ds_write_b128 v88, v[124:127] offset:0
    ds_write_b128 v89, v[128:131] offset:1024
    ds_write_b128 v90, v[132:135] offset:2048
    ds_write_b128 v91, v[136:139] offset:3072
    ds_read_b128 v[124:127], v92 offset:0
    ds_read_b128 v[128:131], v93 offset:0
    ds_read_b128 v[132:135], v94 offset:0
    ds_read_b128 v[136:139], v95 offset:0
    s_waitcnt lgkmcnt(6)
    ds_write_b128 v88, v[140:143] offset:4096
    ds_write_b128 v89, v[144:147] offset:5120
    ds_write_b128 v90, v[148:151] offset:6144
    ds_write_b128 v91, v[152:155] offset:7168
    ds_read_b128 v[140:143], v92 offset:4096
    ds_read_b128 v[144:147], v93 offset:4096
    ds_read_b128 v[148:151], v94 offset:4096
    ds_read_b128 v[152:155], v95 offset:4096
    s_waitcnt lgkmcnt(6)
    ds_write_b128 v88, v[156:159] offset:0
    ds_write_b128 v89, v[160:163] offset:1024
    ds_write_b128 v90, v[164:167] offset:2048
    ds_write_b128 v91, v[168:171] offset:3072
    ds_read_b128 v[156:159], v92 offset:0
    ds_read_b128 v[160:163], v93 offset:0
    ds_read_b128 v[164:167], v94 offset:0
    ds_read_b128 v[168:171], v95 offset:0
    s_waitcnt lgkmcnt(6)
    ds_write_b128 v88, v[172:175] offset:4096
    ds_write_b128 v89, v[176:179] offset:5120
    ds_write_b128 v90, v[180:183] offset:6144
    ds_write_b128 v91, v[184:187] offset:7168
    ds_read_b128 v[172:175], v92 offset:4096
    ds_read_b128 v[176:179], v93 offset:4096
    ds_read_b128 v[180:183], v94 offset:4096
    ds_read_b128 v[184:187], v95 offset:4096
    v_mov_b32 v106, 110592
    ds_read_b32 v105, v106
    v_lshlrev_b32 v104, 4, v0
    v_add_u32 v104, 109568, v104
    s_waitcnt lgkmcnt(0)
    v_cmp_eq_u32 vcc, 0, v105
    s_cbranch_vccnz L_vrest
    s_mov_b32 s70, 1
    s_branch L_qf_ok
L_res2:
    ds_read_u16 v43, v31
    s_waitcnt lgkmcnt(0)
    v_lshlrev_b32 v43, 16, v43
    s_branch L_q2
L_pv1:
    v_pk_add_f32 v[104:105], v[104:105], v[106:107]
    v_add_f32 v109, v104, v105
    s_nop 1
    v_add_f32_dpp v109, v109, v109 row_ror:4 row_mask:0xf bank_mask:0xf
    s_nop 1
    v_add_f32_dpp v109, v109, v109 row_ror:8 row_mask:0xf bank_mask:0xf
    v_mov_b32 v110, v109
    s_nop 1
    v_permlane16_swap_b32 v109, v110
    v_add_f32 v109, v109, v110
    v_mov_b32 v110, v109
    s_nop 1
    v_permlane32_swap_b32 v109, v110
    v_add_f32 v109, v109, v110
    ds_write_b64 v17, v[108:109]
    s_cmp_eq_u32 s70, 1
    s_cbranch_scc1 L_vrest
L_pv1b:
    s_waitcnt vmcnt(60)
    v_perm_b32 v188, v192, v190, s83
    v_perm_b32 v189, v193, v191, s83
    v_perm_b32 v190, v192, v190, s84
    v_perm_b32 v191, v193, v191, s84
    s_waitcnt vmcnt(56)
    v_perm_b32 v192, v196, v194, s83
    v_perm_b32 v193, v197, v195, s83
    v_perm_b32 v194, v196, v194, s84
    v_perm_b32 v195, v197, v195, s84
    v_mfma_f32_4x4x4_16b_bf16 v[88:91], v[112:113], v[188:189], 0 cbsz:4 abid:0
    v_mfma_f32_4x4x4_16b_bf16 v[92:95], v[112:113], v[190:191], 0 cbsz:4 abid:0
    s_waitcnt vmcnt(52)
    v_perm_b32 v196, v200, v198, s83
    v_perm_b32 v197, v201, v199, s83
    v_perm_b32 v198, v200, v198, s84
    v_perm_b32 v199, v201, v199, s84
    v_mfma_f32_4x4x4_16b_bf16 v[88:91], v[112:113], v[192:193], v[88:91] cbsz:4 abid:1
    v_mfma_f32_4x4x4_16b_bf16 v[92:95], v[112:113], v[194:195], v[92:95] cbsz:4 abid:1
    s_waitcnt vmcnt(48)
    v_perm_b32 v200, v204, v202, s83
    v_perm_b32 v201, v205, v203, s83
    v_perm_b32 v202, v204, v202, s84
    v_perm_b32 v203, v205, v203, s84
    v_mfma_f32_4x4x4_16b_bf16 v[88:91], v[112:113], v[196:197], v[88:91] cbsz:4 abid:2
    v_mfma_f32_4x4x4_16b_bf16 v[92:95], v[112:113], v[198:199], v[92:95] cbsz:4 abid:2
    s_waitcnt vmcnt(44)
    v_perm_b32 v204, v208, v206, s83
    v_perm_b32 v205, v209, v207, s83
    v_perm_b32 v206, v208, v206, s84
    v_perm_b32 v207, v209, v207, s84
    v_mfma_f32_4x4x4_16b_bf16 v[88:91], v[112:113], v[200:201], v[88:91] cbsz:4 abid:3
    v_mfma_f32_4x4x4_16b_bf16 v[92:95], v[112:113], v[202:203], v[92:95] cbsz:4 abid:3
    s_waitcnt vmcnt(40)
    v_perm_b32 v208, v212, v210, s83
    v_perm_b32 v209, v213, v211, s83
    v_perm_b32 v210, v212, v210, s84
    v_perm_b32 v211, v213, v211, s84
    v_mfma_f32_4x4x4_16b_bf16 v[88:91], v[112:113], v[204:205], v[88:91] cbsz:4 abid:4
    v_mfma_f32_4x4x4_16b_bf16 v[92:95], v[112:113], v[206:207], v[92:95] cbsz:4 abid:4
    s_waitcnt vmcnt(36)
    v_perm_b32 v212, v216, v214, s83
    v_perm_b32 v213, v217, v215, s83
    v_perm_b32 v214, v216, v214, s84
    v_perm_b32 v215, v217, v215, s84
    v_mfma_f32_4x4x4_16b_bf16 v[88:91], v[112:113], v[208:209], v[88:91] cbsz:4 abid:5
    v_mfma_f32_4x4x4_16b_bf16 v[92:95], v[112:113], v[210:211], v[92:95] cbsz:4 abid:5
    s_waitcnt vmcnt(32)
    v_perm_b32 v216, v220, v218, s83
    v_perm_b32 v217, v221, v219, s83
    v_perm_b32 v218, v220, v218, s84
    v_perm_b32 v219, v221, v219, s84
    v_mfma_f32_4x4x4_16b_bf16 v[88:91], v[112:113], v[212:213], v[88:91] cbsz:4 abid:6
    v_mfma_f32_4x4x4_16b_bf16 v[92:95], v[112:113], v[214:215], v[92:95] cbsz:4 abid:6
    s_waitcnt vmcnt(28)
    v_perm_b32 v220, v224, v222, s83
    v_perm_b32 v221, v225, v223, s83
    v_perm_b32 v222, v224, v222, s84
    v_perm_b32 v223, v225, v223, s84
    v_mfma_f32_4x4x4_16b_bf16 v[88:91], v[112:113], v[216:217], v[88:91] cbsz:4 abid:7
    v_mfma_f32_4x4x4_16b_bf16 v[92:95], v[112:113], v[218:219], v[92:95] cbsz:4 abid:7
    s_waitcnt vmcnt(24)
    v_perm_b32 v224, v228, v226, s83
    v_perm_b32 v225, v229, v227, s83
    v_perm_b32 v226, v228, v226, s84
    v_perm_b32 v227, v229, v227, s84
    v_mfma_f32_4x4x4_16b_bf16 v[88:91], v[112:113], v[220:221], v[88:91] cbsz:4 abid:8
    v_mfma_f32_4x4x4_16b_bf16 v[92:95], v[112:113], v[222:223], v[92:95] cbsz:4 abid:8
    s_waitcnt vmcnt(20)
    v_perm_b32 v228, v232, v230, s83
    v_perm_b32 v229, v233, v231, s83
    v_perm_b32 v230, v232, v230, s84
    v_perm_b32 v231, v233, v231, s84
    v_mfma_f32_4x4x4_16b_bf16 v[88:91], v[112:113], v[224:225], v[88:91] cbsz:4 abid:9
    v_mfma_f32_4x4x4_16b_bf16 v[92:95], v[112:113], v[226:227], v[92:95] cbsz:4 abid:9
    s_waitcnt vmcnt(16)
    v_perm_b32 v232, v236, v234, s83
    v_perm_b32 v233, v237, v235, s83
    v_perm_b32 v234, v236, v234, s84
    v_perm_b32 v235, v237, v235, s84
    v_mfma_f32_4x4x4_16b_bf16 v[88:91], v[112:113], v[228:229], v[88:91] cbsz:4 abid:10
    v_mfma_f32_4x4x4_16b_bf16 v[92:95], v[112:113], v[230:231], v[92:95] cbsz:4 abid:10
    s_waitcnt vmcnt(12)
    v_perm_b32 v236, v240, v238, s83
    v_perm_b32 v237, v241, v239, s83
    v_perm_b32 v238, v240, v238, s84
    v_perm_b32 v239, v241, v239, s84
    v_mfma_f32_4x4x4_16b_bf16 v[88:91], v[112:113], v[232:233], v[88:91] cbsz:4 abid:11
    v_mfma_f32_4x4x4_16b_bf16 v[92:95], v[112:113], v[234:235], v[92:95] cbsz:4 abid:11
    s_waitcnt vmcnt(8)
    v_perm_b32 v240, v244, v242, s83
    v_perm_b32 v241, v245, v243, s83
    v_perm_b32 v242, v244, v242, s84
    v_perm_b32 v243, v245, v243, s84
    v_mfma_f32_4x4x4_16b_bf16 v[88:91], v[112:113], v[236:237], v[88:91] cbsz:4 abid:12
    v_mfma_f32_4x4x4_16b_bf16 v[92:95], v[112:113], v[238:239], v[92:95] cbsz:4 abid:12
    s_waitcnt vmcnt(4)
    v_perm_b32 v244, v248, v246, s83
    v_perm_b32 v245, v249, v247, s83
    v_perm_b32 v246, v248, v246, s84
    v_perm_b32 v247, v249, v247, s84
    v_mfma_f32_4x4x4_16b_bf16 v[88:91], v[112:113], v[240:241], v[88:91] cbsz:4 abid:13
    v_mfma_f32_4x4x4_16b_bf16 v[92:95], v[112:113], v[242:243], v[92:95] cbsz:4 abid:13
    s_waitcnt vmcnt(0)
    v_perm_b32 v248, v252, v250, s83
    v_perm_b32 v249, v253, v251, s83
    v_perm_b32 v250, v252, v250, s84
    v_perm_b32 v251, v253, v251, s84
    v_mfma_f32_4x4x4_16b_bf16 v[88:91], v[112:113], v[244:245], v[88:91] cbsz:4 abid:14
    v_mfma_f32_4x4x4_16b_bf16 v[92:95], v[112:113], v[246:247], v[92:95] cbsz:4 abid:14
    s_nop 0
    v_mfma_f32_4x4x4_16b_bf16 v[88:91], v[112:113], v[248:249], v[88:91] cbsz:4 abid:15
    v_mfma_f32_4x4x4_16b_bf16 v[92:95], v[112:113], v[250:251], v[92:95] cbsz:4 abid:15
    s_nop 2
    s_branch L_pv3
L_late:
    v_mov_b32 v109, 110596
    ds_read_b32 v47, v109
    s_barrier
    v_bfe_u32 v46, v0, 2, 2
    v_lshl_add_u32 v46, v1, 3, v46
    v_lshlrev_b32 v46, 10, v46
    v_and_b32 v111, 1, v1
    v_lshlrev_b32 v111, 1, v111
    v_xor_b32 v111, v111, v0
    v_and_b32 v111, 3, v111
    v_lshl_add_u32 v46, v111, 4, v46
    s_lshr_b32 s77, s3, 2
    s_lshl_b32 s77, s77, 18
    s_add_u32 s76, s77, 0
    s_add_u32 m0, s78, 2048
    s_nop 0
    buffer_load_dwordx4 v46, s[48:51], s76 offen  lds
    s_add_u32 s76, s77, 4096
    s_add_u32 m0, s78, 3072
    s_nop 0
    buffer_load_dwordx4 v46, s[48:51], s76 offen  lds
    s_add_u32 s76, s77, 32768
    s_add_u32 m0, s78, 4096
    s_nop 0
    buffer_load_dwordx4 v46, s[48:51], s76 offen  lds
    s_add_u32 s76, s77, 36864
    s_add_u32 m0, s78, 5120
    s_nop 0
    buffer_load_dwordx4 v46, s[48:51], s76 offen  lds
    s_sub_u32 s76, s3, 1
    s_lshl1_add_u32 s75, s65, s76
    s_cmp_lt_u32 s76, 2
    s_cselect_b32 s75, s75, 96
    s_cmp_lt_u32 s75, 64
    s_cbranch_scc0 L_pf_d
    s_and_b32 s76, s75, 31
    s_mul_i32 s76, s76, 57344
    s_mul_i32 s77, s64, 448
    s_add_u32 s76, s76, s77
    v_lshrrev_b32 v111, 2, v0
    v_mul_u32_u24 v111, 3584, v111
    v_and_b32 v46, 3, v0
    v_lshl_add_u32 v111, v46, 7, v111
    s_cmp_lt_u32 s75, 32
    s_cselect_b32 s40, s16, s18
    s_cselect_b32 s41, s17, s19
    s_mov_b32 s42, 1835008
    s_branch L_pf_go
L_pf_d:
    s_sub_u32 s76, s75, 64
    s_lshl_b32 s76, s76, 13
    s_mul_i32 s77, s64, 229376
    s_add_u32 s76, s76, s77
    v_lshlrev_b32 v111, 7, v0
    s_mov_b32 s40, s20
    s_mov_b32 s41, s21
    s_cmp_lt_u32 s75, 0
    s_cselect_b32 s42, 1835008, 0
L_pf_go:
    s_mov_b32 s43, 0x20000
    buffer_load_dword v122, v111, s[40:43], s76 offen
    s_cmp_eq_u32 s64, 0
    s_cbranch_scc0 L_nolate
    ds_read_u16 v43, v31
    s_waitcnt lgkmcnt(0)
    v_lshlrev_b32 v43, 16, v43
    s_branch L_nolate
L_yw:
    s_cmp_eq_u32 s72, 0
    s_cbranch_scc0 L_wo
    s_cmp_eq_u32 s3, 7
    s_cbranch_scc0 L_yw1
    v_and_b32 v120, 7, v0
    v_lshlrev_b32 v120, 7, v120
    v_add_u32 v120, 32772, v120
    buffer_load_dword v119, v120, s[36:39], 0 offen sc1
L_yw1:
    v_bfe_u32 v46, v0, 2, 2
    v_lshl_add_u32 v46, v1, 3, v46
    v_lshlrev_b32 v46, 10, v46
    v_and_b32 v111, 1, v1
    v_lshlrev_b32 v111, 1, v111
    v_xor_b32 v111, v111, v0
    v_and_b32 v111, 3, v111
    v_lshl_add_u32 v46, v111, 4, v46
    s_lshr_b32 s77, s3, 2
    s_lshl_b32 s77, s77, 18
    s_add_u32 s76, s77, 0
    s_add_u32 m0, s78, 2048
    s_nop 0
    buffer_load_dwordx4 v46, s[48:51], s76 offen  lds
    s_add_u32 s76, s77, 4096
    s_add_u32 m0, s78, 3072
    s_nop 0
    buffer_load_dwordx4 v46, s[48:51], s76 offen  lds
    s_add_u32 s76, s77, 32768
    s_add_u32 m0, s78, 4096
    s_nop 0
    buffer_load_dwordx4 v46, s[48:51], s76 offen  lds
    s_add_u32 s76, s77, 36864
    s_add_u32 m0, s78, 5120
    s_nop 0
    buffer_load_dwordx4 v46, s[48:51], s76 offen  lds
    s_branch L_wo
L_gf:
    v_and_b32 v120, 7, v0
    v_lshlrev_b32 v120, 7, v120
    v_add_u32 v120, 32772, v120
    buffer_load_dword v119, v120, s[36:39], 0 offen sc1
    s_waitcnt vmcnt(0)
L_gf0:
    v_cmp_ne_u32 vcc, v119, v47
    s_cbranch_vccz L_gf1
    s_sub_u32 s71, s71, 1
    s_cbranch_scc0 L_gf
    s_mov_b32 s71, 0
L_gf1:
    s_lshl_b32 s76, s68, 10
    s_add_u32 s76, s76, 458752
    v_lshl_add_u32 v116, v0, 4, s76
    v_mov_b32 v96, s68
    v_mov_b32 v97, s79
    v_cmp_lt_u32 vcc, 1, v1
    s_nop 1
    v_cndmask_b32 v96, v96, v97, vcc
    v_lshrrev_b32 v97, 3, v0
    v_lshlrev_b32 v98, 15, v97
    v_lshl_add_u32 v117, v96, 7, v98
    v_and_b32 v98, 7, v0
    v_lshl_add_u32 v117, v98, 4, v117
    v_add_u32 v117, 65536, v117
    s_lshl_b32 s76, s68, 7
    s_add_u32 s76, s76, 327680
    v_lshlrev_b32 v97, 22, v97
    v_lshl_add_u32 v118, v98, 4, v97
    v_add_u32 v118, s76, v118
    s_mov_b32 s77, 327680
    v_mov_b32 v100, -1
    v_mov_b32 v101, -1
    v_mov_b32 v102, -1
    v_mov_b32 v103, -1
    buffer_store_dwordx4 v[100:103], v116, s[36:39], s77 offen sc1
    buffer_store_dwordx4 v[100:103], v118, s[36:39], 0 offen sc1
    s_mov_b32 exec_lo, 0xff00ff00
    s_mov_b32 exec_hi, 0xff00ff00
    buffer_store_dwordx4 v[100:103], v117, s[36:39], 0 offen sc1
    s_mov_b64 exec, -1
    s_branch L_gf_ok
L_nogu:
    s_cmp_eq_u32 s72, 0
    s_cbranch_scc0 L_dn
    s_sub_u32 s75, s65, 14
    s_sub_u32 s76, s3, 1
    s_lshl1_add_u32 s75, s75, s76
    s_cmp_lt_u32 s76, 2
    s_cselect_b32 s75, s75, 28
    s_cmp_lt_u32 s75, 28
    s_cselect_b32 s42, 1835008, 0
    s_lshl_b32 s76, s75, 13
    s_mul_i32 s77, s64, 229376
    s_add_u32 s76, s76, s77
    v_lshlrev_b32 v111, 7, v0
    s_mov_b32 s40, s20
    s_mov_b32 s41, s21
    s_mov_b32 s43, 0x20000
    buffer_load_dword v122, v111, s[40:43], s76 offen
    s_waitcnt vmcnt(0)
    s_barrier
    v_lshl_add_u32 v46, v39, 10, v40
    s_add_u32 m0, s78, 10240
    s_nop 0
    buffer_load_dwordx4 v46, s[4:7], 0 offen  lds
    s_cmp_eq_u32 s3, 7
    s_cbranch_scc0 L_nw2
    s_lshl_b32 s76, s68, 10
    s_add_u32 s76, s76, 458752
    v_lshl_add_u32 v116, v0, 4, s76
    v_mov_b32 v106, s68
    v_mov_b32 v107, s79
    v_cmp_lt_u32 vcc, 1, v1
    s_nop 1
    v_cndmask_b32 v106, v106, v107, vcc
    v_lshrrev_b32 v107, 3, v0
    v_lshlrev_b32 v108, 15, v107
    v_lshl_add_u32 v117, v106, 7, v108
    v_and_b32 v108, 7, v0
    v_lshl_add_u32 v117, v108, 4, v117
    v_add_u32 v117, 65536, v117
    s_lshl_b32 s76, s68, 7
    s_add_u32 s76, s76, 327680
    v_lshlrev_b32 v107, 22, v107
    v_lshl_add_u32 v118, v108, 4, v107
    v_add_u32 v118, s76, v118
    s_mov_b32 s77, 327680
    s_mov_b32 exec_lo, 0x01010101
    s_mov_b32 exec_hi, 0x01010101
    buffer_load_dword v122, v116, s[36:39], s77 offen sc1
    s_mov_b64 exec, 1
    buffer_load_dword v122, v118, s[36:39], 0 offen sc1
    s_mov_b32 exec_lo, 0x01000100
    buffer_load_dword v122, v117, s[36:39], 0 offen sc1
    s_mov_b64 exec, -1
    s_cmp_lt_u32 s65, 28
    s_cbranch_scc0 L_dn
    v_subrev_u32 v116, 14336, v116
    v_subrev_u32 v118, 1792, v118
    v_subrev_u32 v117, 1792, v117
    s_mov_b32 exec_lo, 0x01010101
    s_mov_b32 exec_hi, 0x01010101
    buffer_load_dword v122, v116, s[36:39], s77 offen sc1
    s_mov_b64 exec, 1
    buffer_load_dword v122, v118, s[36:39], 0 offen sc1
    s_mov_b32 exec_lo, 0x01000100
    buffer_load_dword v122, v117, s[36:39], 0 offen sc1
    s_mov_b64 exec, -1
    s_branch L_dn
L_nw2:
    s_xor_b32 s75, s2, 255
    s_or_b32 s75, s75, s72
    s_or_b32 s75, s75, s3
    s_cbranch_scc1 L_dn
    v_mov_b32 v109, 110596
    ds_read_b32 v88, v109
    v_lshlrev_b32 v109, 4, v0
    s_waitcnt lgkmcnt(0)
    v_mov_b32 v89, v88
    v_mov_b32 v90, v88
    v_mov_b32 v91, v88
    s_mov_b64 exec, 0xff
    buffer_store_dwordx4 v[88:91], v109, s[36:39], 0 offen sc1
    s_mov_b64 exec, -1
    s_branch L_dn
L_gu0:
    v_mul_u32_u24 v46, 3584, v39
    v_add_u32 v46, v46, v40
    s_mov_b32 s75, 114688
    s_add_u32 m0, s78, 8192
    s_nop 0
    buffer_load_dwordx4 v46, s[56:59], 0 offen  lds
    s_add_u32 m0, s78, 9216
    s_nop 0
    buffer_load_dwordx4 v46, s[56:59], s75 offen  lds
    s_waitcnt vmcnt(2)
    s_branch L_gu1
L_dn7:
    s_waitcnt vmcnt(0)
    s_branch L_dn1
L_x1:
    s_waitcnt vmcnt(0)
L_pr:
    buffer_load_dword v104, v29, s[36:39], s72 offen offset:0 sc1
    buffer_load_dword v105, v29, s[36:39], s72 offen offset:128 sc1
    buffer_load_dword v106, v29, s[36:39], s72 offen offset:256 sc1
    buffer_load_dword v107, v29, s[36:39], s72 offen offset:384 sc1
    s_waitcnt vmcnt(3)
    s_waitcnt vmcnt(2)
    s_waitcnt vmcnt(1)
    v_max3_u32 v123, v104, v105, v106
    s_waitcnt vmcnt(0)
    v_max_u32 v123, v107, v123
    v_cmp_eq_u32 vcc, -1, v123
    s_cbranch_vccnz L_pr_again
L_pr_ok:
    v_add_f32 v104, v104, v105
    v_add_f32 v106, v106, v107
    v_add_f32 v44, v104, v106
    v_mov_b32 v104, v44
    s_nop 1
    v_permlane32_swap_b32 v44, v104
    v_add_f32 v44, v44, v104
    v_cvt_pk_bf16_f32 v44, v44, v44
    v_and_b32 v44, 0xffff0000, v44
    s_branch L_dn0
L_hq_again:
    s_sub_u32 s71, s71, 1
    s_cbranch_scc0 L_hq
    s_mov_b32 s71, 0
    s_branch L_hq_ok
L_qf_again:
    s_sub_u32 s71, s71, 1
    s_cbranch_scc0 L_qf
    s_mov_b32 s71, 0
    s_branch L_qf_ok
L_pd_again:
    s_sub_u32 s71, s71, 1
    s_cbranch_scc0 L_pd
    s_mov_b32 s71, 0
    s_branch L_pd_ok
L_sq_wt:
    buffer_store_dwordx4 v[96:99], v37, s[36:39], 0 offen sc1
    s_branch L_sq_e
L_pq_again:
    s_sub_u32 s71, s71, 1
    s_cbranch_scc0 L_pq
    s_mov_b32 s71, 0
    s_branch L_pq_ok
L_so_wt:
    buffer_store_dword v109, v32, s[36:39], s73 offen sc1
    s_mov_b64 exec, 1
    buffer_store_dwordx2 v[106:107], v33, s[36:39], s72 offen sc1
    s_branch L_so_e
L_pa_again:
    s_sub_u32 s71, s71, 1
    s_cbranch_scc0 L_pa
    s_mov_b32 s71, 0
    s_branch L_pa_ok
L_pb_again:
    s_sub_u32 s71, s71, 1
    s_cbranch_scc0 L_pb
    s_mov_b32 s71, 0
    s_branch L_pb_ok
L_sh_wt:
    buffer_store_dwordx4 v[96:99], v36, s[36:39], s75 offen sc1
    s_branch L_sh_e
L_pr_again:
    s_sub_u32 s71, s71, 1
    s_cbranch_scc0 L_pr
    s_mov_b32 s71, 0
    s_branch L_pr_ok
L_pc2_again:
    s_sub_u32 s71, s71, 1
    s_cbranch_scc0 L_pc2
    s_mov_b32 s71, 0
    s_branch L_pc2_ok
L_pf_again:
    s_sub_u32 s71, s71, 1
    s_cbranch_scc0 L_pf
    s_mov_b32 s71, 0
    s_branch L_pf_ok
L_codeend:
s_endpgm
.section .rodata,"a"
.p2align 6
.amdhsa_kernel interleave_layers__gqa_block_cached__glu_gated_reglu__decode_kernel
  .amdhsa_next_free_vgpr 256
  .amdhsa_next_free_sgpr 102
  .amdhsa_accum_offset 256
  .amdhsa_group_segment_fixed_size 0
  .amdhsa_kernarg_size 96
  .amdhsa_user_sgpr_count 2
  .amdhsa_user_sgpr_kernarg_segment_ptr 1
  .amdhsa_system_sgpr_workgroup_id_x 1
.end_amdhsa_kernel
```
